```python
import torch

def _softmax(x, axis=-1):
    return torch.softmax(x, dim=axis)
def _gelu(x):
    return torch.nn.functional.gelu(x, approximate="tanh")
def _silu(x):
    return torch.nn.functional.silu(x)
def _sigmoid(x):
    return torch.sigmoid(x)
def _layernorm(x, axis=-1, eps=1e-5):
    m = x.mean(dim=axis, keepdim=True)
    v = x.var(dim=axis, keepdim=True, unbiased=False)
    return (x - m) / torch.sqrt(v + eps)
def _scatter_add(tgt, idx, src, axis=0):
    return tgt.clone().index_add_(axis, idx, src)
def _segment_sum(src, seg, n):
    out = torch.zeros((n,) + src.shape[1:], dtype=src.dtype)
    return out.index_add_(0, seg, src)
def _pad(x, pw):
    flat = tuple(v for pair in reversed(pw) for v in pair)
    return torch.nn.functional.pad(x, flat)

kernel_name = 'standalone__gqa_block_cached__decode'

def setup_inputs():

    _w = (lambda a: (lambda t: t.to(torch.bfloat16) if t.is_floating_point() else t)(torch.as_tensor(a)))
    B, Sq, D = 2, 1, 576
    Hq, Hkv, Sk, Dh = 32, 16, 32768, 128
    assert Hq % Hkv == 0, (Hq, Hkv)
    return {
        "x": _w((lambda *s: torch.randn(*s, dtype=torch.bfloat16) * 0.8)(B, Sq, D)),
        "k_cache": _w((lambda *s: torch.randn(*s, dtype=torch.bfloat16) * 0.8)(B, Hkv, Sk, Dh)),
        "v_cache": _w((lambda *s: torch.randn(*s, dtype=torch.bfloat16) * 0.05)(B, Hkv, Sk, Dh)),
        "wq": _w((lambda *s: torch.randn(*s, dtype=torch.bfloat16) * 0.8)(D, Hq * Dh) * (D ** -0.5)),
        "wo": _w((lambda *s: torch.randn(*s, dtype=torch.bfloat16) * 0.05)(Hq * Dh, D) * ((Hq * Dh) ** -0.5)),
    }

def reference(x, k_cache, v_cache, wq, wo):
    B, Sq, D = x.shape
    Hq, Dh = 32, 128
    Hkv = k_cache.shape[1]
    rep = Hq // Hkv
    q = (lambda x, *d: x.permute(*d))((x @ wq).reshape(B, Sq, Hq, Dh), 0, 2, 1, 3)
    k = (lambda x, n, axis: torch.repeat_interleave(x, n, dim=axis))(k_cache, rep, axis=1)
    v = (lambda x, n, axis: torch.repeat_interleave(x, n, dim=axis))(v_cache, rep, axis=1)
    scores = torch.einsum("bhqd,bhkd->bhqk", q, k) * (Dh ** -0.5)
    p = _softmax(scores, axis=-1)
    o = torch.einsum("bhqk,bhkd->bhqd", p, v)
    return (lambda x, *d: x.permute(*d))(o, 0, 2, 1, 3).reshape(B, Sq, Hq * Dh) @ wo
```

```asm
; @launch grid=(256,1,1) block=(512,1,1) lds=160512
.amdgcn_target "amdgcn-amd-amdhsa--gfx950"
.text
.globl standalone__gqa_block_cached__decode_kernel
.p2align 8
.type standalone__gqa_block_cached__decode_kernel,@function
standalone__gqa_block_cached__decode_kernel:
  s_cmp_ge_u32 s2, 256
  s_cbranch_scc1 L_end
  s_load_dwordx16 s[4:19], s[0:1], 0
  s_memrealtime s[70:71]
  v_and_b32 v1, 63, v0
  v_lshrrev_b32 v13, 6, v0
  v_lshrrev_b32 v2, 4, v1
  v_readfirstlane_b32 s40, v13
  v_and_b32 v3, 15, v1
  s_and_b32 s42, s2, 7
  s_lshr_b32 s41, s2, 3
  s_lshl_b32 s47, s42, 2
  s_add_u32 s41, s41, s47
  s_and_b32 s41, s41, 31
  s_and_b32 s56, s2, 31
  s_lshr_b32 s57, s2, 5
  s_and_b32 s52, s56, 15
  s_lshr_b32 s53, s56, 4
  s_lshl_b32 s43, s56, 3
  s_add_u32 s43, s43, s57
  s_lshl_b32 s43, s43, 11
  v_lshlrev_b32 v5, 4, v1
  s_mov_b32 s23, 0x20000
  s_mov_b32 s27, 0x20000
  s_mov_b32 s31, 0x20000
  s_mov_b32 s35, 0x20000
  s_mov_b32 s39, 0x20000
  s_mov_b32 s38, 0x200000
  s_lshl_b32 s55, s41, 3
  s_add_u32 s55, s55, s42
  s_lshl_b32 s55, s55, 11
  s_mov_b32 s58, 0x200000
  v_mov_b32 v10, 0xff7fffff
  v_mov_b32 v11, 0xff7fffff
  v_mov_b32 v12, 0
  v_mov_b32 v26, 160384
  s_cmp_lg_u32 s40, 0
  s_cbranch_scc1 L_notloader
  s_setprio 3
  v_and_b32 v13, 3, v3
  v_lshlrev_b32 v13, 2, v13
  v_lshrrev_b32 v14, 2, v3
  v_add_u32 v13, v13, v14
  v_lshlrev_b32 v13, 8, v13
  v_lshl_add_u32 v48, v2, 4, v13
  v_add_u32 v49, 64, v48
  v_add_u32 v50, 128, v48
  v_add_u32 v51, 192, v48
  s_lshl_b32 s64, s42, 20
  s_mov_b32 s22, 0x800000
  s_mov_b32 s26, 0x800000
  s_lshl_b32 s50, s41, 23
  s_lshr_b32 s51, s41, 9
  s_mov_b32 s62, 0
  s_mov_b32 s66, 0
  s_mov_b32 s67, 0
  s_mov_b32 s69, 0
  s_mov_b32 s72, 0
  s_waitcnt lgkmcnt(0)
  s_add_u32 s20, s6, s50
  s_addc_u32 s21, s7, s51
  s_add_u32 s24, s8, s50
  s_addc_u32 s25, s9, s51
  s_mov_b32 s36, s18
  s_mov_b32 s37, s19
  s_mov_b32 s67, -4
  s_add_u32 s65, s64, 0x1000
  s_add_u32 m0, s66, 0
  s_waitcnt vmcnt(28)
  buffer_load_dwordx4 v48, s[20:23], s64 offen nt lds
  s_add_u32 m0, s66, 1024
  s_nop 0
  buffer_load_dwordx4 v49, s[20:23], s64 offen nt lds
  s_add_u32 m0, s66, 2048
  s_nop 0
  buffer_load_dwordx4 v50, s[20:23], s64 offen nt lds
  s_add_u32 m0, s66, 3072
  s_nop 0
  buffer_load_dwordx4 v51, s[20:23], s64 offen nt lds
  s_add_u32 m0, s66, 4096
  s_waitcnt vmcnt(28)
  s_add_u32 s67, s67, 1
  buffer_load_dwordx4 v48, s[20:23], s65 offen nt lds
  s_add_u32 m0, s66, 5120
  s_nop 0
  buffer_load_dwordx4 v49, s[20:23], s65 offen nt lds
  s_add_u32 m0, s66, 6144
  s_nop 0
  buffer_load_dwordx4 v50, s[20:23], s65 offen nt lds
  s_add_u32 m0, s66, 7168
  s_nop 0
  buffer_load_dwordx4 v51, s[20:23], s65 offen nt lds
  s_add_u32 m0, s66, 8192
  s_waitcnt vmcnt(28)
  buffer_load_dwordx4 v5, s[24:27], s64 offen offset:0 nt lds
  buffer_load_dwordx4 v5, s[24:27], s64 offen offset:1024 nt lds
  buffer_load_dwordx4 v5, s[24:27], s64 offen offset:2048 nt lds
  buffer_load_dwordx4 v5, s[24:27], s64 offen offset:3072 nt lds
  s_add_u32 m0, s66, 12288
  s_waitcnt vmcnt(28)
  s_add_u32 s67, s67, 1
  buffer_load_dwordx4 v5, s[24:27], s65 offen offset:0 nt lds
  buffer_load_dwordx4 v5, s[24:27], s65 offen offset:1024 nt lds
  buffer_load_dwordx4 v5, s[24:27], s65 offen offset:2048 nt lds
  buffer_load_dwordx4 v5, s[24:27], s65 offen offset:3072 nt lds
  s_add_u32 s64, s64, 0x2000
  s_add_u32 s66, s66, 16384
  s_cmp_ge_u32 s66, 147456
  s_cselect_b32 s66, 0, s66
  s_add_u32 s62, s62, 1
  s_add_u32 s65, s64, 0x1000
  s_add_u32 m0, s66, 0
  s_waitcnt vmcnt(28)
  buffer_load_dwordx4 v48, s[20:23], s64 offen nt lds
  s_add_u32 m0, s66, 1024
  s_nop 0
  buffer_load_dwordx4 v49, s[20:23], s64 offen nt lds
  s_add_u32 m0, s66, 2048
  s_nop 0
  buffer_load_dwordx4 v50, s[20:23], s64 offen nt lds
  s_add_u32 m0, s66, 3072
  s_nop 0
  buffer_load_dwordx4 v51, s[20:23], s64 offen nt lds
  s_add_u32 m0, s66, 4096
  s_waitcnt vmcnt(28)
  s_add_u32 s67, s67, 1
  buffer_load_dwordx4 v48, s[20:23], s65 offen nt lds
  s_add_u32 m0, s66, 5120
  s_nop 0
  buffer_load_dwordx4 v49, s[20:23], s65 offen nt lds
  s_add_u32 m0, s66, 6144
  s_nop 0
  buffer_load_dwordx4 v50, s[20:23], s65 offen nt lds
  s_add_u32 m0, s66, 7168
  s_nop 0
  buffer_load_dwordx4 v51, s[20:23], s65 offen nt lds
  s_add_u32 m0, s66, 8192
  s_waitcnt vmcnt(28)
  buffer_load_dwordx4 v5, s[24:27], s64 offen offset:0 nt lds
  buffer_load_dwordx4 v5, s[24:27], s64 offen offset:1024 nt lds
  buffer_load_dwordx4 v5, s[24:27], s64 offen offset:2048 nt lds
  buffer_load_dwordx4 v5, s[24:27], s64 offen offset:3072 nt lds
  s_add_u32 m0, s66, 12288
  s_waitcnt vmcnt(28)
  s_add_u32 s67, s67, 1
  buffer_load_dwordx4 v5, s[24:27], s65 offen offset:0 nt lds
  buffer_load_dwordx4 v5, s[24:27], s65 offen offset:1024 nt lds
  buffer_load_dwordx4 v5, s[24:27], s65 offen offset:2048 nt lds
  buffer_load_dwordx4 v5, s[24:27], s65 offen offset:3072 nt lds
  s_add_u32 s64, s64, 0x2000
  s_add_u32 s66, s66, 16384
  s_cmp_ge_u32 s66, 147456
  s_cselect_b32 s66, 0, s66
  s_add_u32 s62, s62, 1
  s_barrier
L_ld_loop:
  s_cmp_lt_u32 s62, 120
  s_cbranch_scc1 L_ld_static
  s_cmp_lg_u32 s69, 0
  s_cbranch_scc1 L_ld_inchunk
  s_add_u32 s72, s72, 1
L_ld_resp:
  ds_read_b32 v15, v26 offset:12
  s_waitcnt lgkmcnt(0)
  v_readfirstlane_b32 s47, v15
  s_lshr_b32 s48, s47, 16
  s_cmp_eq_u32 s48, s72
  s_cbranch_scc1 L_ld_respok
  s_sub_u32 s58, s58, 1
  s_cmp_lg_u32 s58, 0
  s_cbranch_scc1 L_ld_resp
  s_branch L_ld_drain
L_ld_respok:
  v_mov_b32 v15, s72
  ds_write_b32 v26, v15 offset:8
  s_and_b32 s47, s47, 0xffff
  s_cmp_ge_u32 s47, 64
  s_cbranch_scc1 L_ld_drain
  s_mul_i32 s73, s47, 1
  s_mov_b32 s69, 1
L_ld_inchunk:
  s_lshr_b32 s47, s73, 3
  s_lshl_b32 s64, s47, 20
  s_and_b32 s47, s73, 7
  s_add_u32 s47, s47, 120
  s_lshl_b32 s47, s47, 13
  s_add_u32 s64, s64, s47
  s_add_u32 s73, s73, 1
  s_sub_u32 s69, s69, 1
L_ld_static:
  s_cmp_lg_u32 s62, 64
  s_cbranch_scc1 L_ld_nowo
  s_mul_i32 s47, s52, 294912
  s_mul_i32 s48, s57, 144
  s_add_u32 s47, s47, s48
  s_add_u32 s28, s12, s47
  s_addc_u32 s29, s13, 0
  s_sub_u32 s30, 4718592, s47
  s_lshr_b32 s47, s40, 2
  s_lshl_b32 s47, s47, 7
  s_and_b32 s48, s40, 3
  s_lshl_b32 s48, s48, 1
  s_add_u32 s47, s47, s48
  s_mul_i32 s54, s47, 1152
  v_min_u32 v15, 8, v3
  v_lshlrev_b32 v15, 4, v15
  v_mul_u32_u24 v16, 36864, v2
  v_add_u32 v6, v15, v16
  buffer_load_dwordx4 v[204:207], v6, s[28:31], s54 offen offset:0 nt
  buffer_load_dwordx4 v[208:211], v6, s[28:31], s54 offen offset:1152 nt
  s_add_u32 s54, s54, 9216
  buffer_load_dwordx4 v[212:215], v6, s[28:31], s54 offen offset:0 nt
  buffer_load_dwordx4 v[216:219], v6, s[28:31], s54 offen offset:1152 nt
  s_add_u32 s54, s54, 9216
  buffer_load_dwordx4 v[220:223], v6, s[28:31], s54 offen offset:0 nt
  buffer_load_dwordx4 v[224:227], v6, s[28:31], s54 offen offset:1152 nt
  s_add_u32 s54, s54, 9216
  buffer_load_dwordx4 v[228:231], v6, s[28:31], s54 offen offset:0 nt
  buffer_load_dwordx4 v[232:235], v6, s[28:31], s54 offen offset:1152 nt
L_ld_nowo:
  s_lshr_b32 s47, s66, 12
  s_add_u32 s47, s47, 160416
  v_mov_b32 v16, s47
  s_sub_u32 s48, s62, 8
L_ld_free:
  ds_read_b32 v15, v16
  s_waitcnt lgkmcnt(0)
  v_readfirstlane_b32 s47, v15
  s_cmp_ge_i32 s47, s48
  s_cbranch_scc1 L_ld_go
  s_sub_u32 s58, s58, 1
  s_cmp_lg_u32 s58, 0
  s_cbranch_scc1 L_ld_free
L_ld_go:
  s_add_u32 s65, s64, 0x1000
  s_add_u32 m0, s66, 0
  s_waitcnt vmcnt(28)
  buffer_load_dwordx4 v48, s[20:23], s64 offen nt lds
  s_add_u32 m0, s66, 1024
  s_nop 0
  buffer_load_dwordx4 v49, s[20:23], s64 offen nt lds
  s_add_u32 m0, s66, 2048
  s_nop 0
  buffer_load_dwordx4 v50, s[20:23], s64 offen nt lds
  s_add_u32 m0, s66, 3072
  s_nop 0
  buffer_load_dwordx4 v51, s[20:23], s64 offen nt lds
  s_add_u32 m0, s66, 4096
  s_waitcnt vmcnt(28)
  s_add_u32 s67, s67, 1
  v_mov_b32 v14, s67
  ds_write_b32 v26, v14
  buffer_load_dwordx4 v48, s[20:23], s65 offen nt lds
  s_add_u32 m0, s66, 5120
  s_nop 0
  buffer_load_dwordx4 v49, s[20:23], s65 offen nt lds
  s_add_u32 m0, s66, 6144
  s_nop 0
  buffer_load_dwordx4 v50, s[20:23], s65 offen nt lds
  s_add_u32 m0, s66, 7168
  s_nop 0
  buffer_load_dwordx4 v51, s[20:23], s65 offen nt lds
  s_add_u32 m0, s66, 8192
  s_waitcnt vmcnt(28)
  buffer_load_dwordx4 v5, s[24:27], s64 offen offset:0 nt lds
  buffer_load_dwordx4 v5, s[24:27], s64 offen offset:1024 nt lds
  buffer_load_dwordx4 v5, s[24:27], s64 offen offset:2048 nt lds
  buffer_load_dwordx4 v5, s[24:27], s64 offen offset:3072 nt lds
  s_add_u32 m0, s66, 12288
  s_waitcnt vmcnt(28)
  s_add_u32 s67, s67, 1
  v_mov_b32 v14, s67
  ds_write_b32 v26, v14
  buffer_load_dwordx4 v5, s[24:27], s65 offen offset:0 nt lds
  buffer_load_dwordx4 v5, s[24:27], s65 offen offset:1024 nt lds
  buffer_load_dwordx4 v5, s[24:27], s65 offen offset:2048 nt lds
  buffer_load_dwordx4 v5, s[24:27], s65 offen offset:3072 nt lds
  s_add_u32 s64, s64, 0x2000
  s_add_u32 s66, s66, 16384
  s_cmp_ge_u32 s66, 147456
  s_cselect_b32 s66, 0, s66
  s_add_u32 s62, s62, 1
  s_branch L_ld_loop
L_ld_drain:
  v_mov_b32 v15, s62
  ds_write_b32 v26, v15 offset:4
  s_waitcnt vmcnt(24)
  s_add_u32 s67, s67, 1
  v_mov_b32 v14, s67
  ds_write_b32 v26, v14
  s_waitcnt vmcnt(16)
  s_add_u32 s67, s67, 1
  v_mov_b32 v14, s67
  ds_write_b32 v26, v14
  s_waitcnt vmcnt(8)
  s_add_u32 s67, s67, 1
  v_mov_b32 v14, s67
  ds_write_b32 v26, v14
  s_waitcnt vmcnt(0)
  s_add_u32 s67, s67, 1
  v_mov_b32 v14, s67
  ds_write_b32 v26, v14
  s_setprio 0
  v_and_b32 v13, 1, v3
  v_bfe_u32 v14, v3, 1, 2
  v_cmp_eq_u32 vcc, 1, v13
  v_mov_b32 v15, 0x0c0c0100
  v_mov_b32 v16, 0x01000c0c
  v_cndmask_b32 v15, v15, v16, vcc
  v_mov_b32 v13, 0x0c0c0302
  v_mov_b32 v16, 0x03020c0c
  v_cndmask_b32 v16, v13, v16, vcc
  v_mov_b32 v13, 0x0c0c0c0c
  v_cmp_eq_u32 vcc, 0, v14
  s_nop 1
  v_cndmask_b32 v18, v13, v15, vcc
  v_cndmask_b32 v19, v13, v16, vcc
  v_cmp_eq_u32 vcc, 1, v14
  s_nop 1
  v_cndmask_b32 v20, v13, v15, vcc
  v_cndmask_b32 v21, v13, v16, vcc
  v_cmp_eq_u32 vcc, 2, v14
  s_nop 1
  v_cndmask_b32 v22, v13, v15, vcc
  v_cndmask_b32 v23, v13, v16, vcc
  v_cmp_eq_u32 vcc, 3, v14
  s_nop 1
  v_cndmask_b32 v24, v13, v15, vcc
  v_cndmask_b32 v25, v13, v16, vcc
  v_mov_b32 v28, 0
  v_mov_b32 v29, 0
  v_mov_b32 v30, 0
  v_mov_b32 v31, 0
  s_branch L_exit
L_notloader:
  v_lshlrev_b32 v13, 2, v1
  v_and_b32 v13, 0x7f, v13
  v_mov_b32 v14, 0
  v_add_u32 v13, 160384, v13
  s_cmp_lg_u32 s40, 7
  s_cbranch_scc1 L_nz
  ds_write_b32 v13, v14
L_nz:
  s_waitcnt lgkmcnt(0)
  s_barrier
L_nobar:
  s_mov_b32 s36, s18
  s_mov_b32 s37, s19
  s_cmp_lg_u32 s40, 1
  s_cbranch_scc1 L_cons
  s_cmp_lg_u32 s2, 0
  s_cbranch_scc1 L_notag
  s_mov_b32 s32, s16
  s_mov_b32 s33, s17
  s_mov_b32 s34, 256
  s_or_b32 s71, s71, 0x80000000
  v_mov_b32 v220, s70
  v_mov_b32 v221, s71
  v_mov_b32 v16, 0
  s_mov_b64 exec, 1
  buffer_store_dwordx2 v[220:221], v16, s[32:35], 0 offen sc1
  s_mov_b64 exec, -1
L_notag:
  v_mov_b32 v28, -1
  v_mov_b32 v29, -1
  v_mov_b32 v30, -1
  v_mov_b32 v31, -1
  buffer_store_dwordx4 v[28:31], v5, s[36:39], s43 offen sc1
  s_mov_b64 exec, 0x7ffff
  buffer_store_dwordx4 v[28:31], v5, s[36:39], s43 offen offset:1264 sc1
  s_lshl_b32 s47, s56, 12
  s_add_u32 s47, s47, 589824
  s_cmp_lg_u32 s57, 0
  s_cbranch_scc1 L_nocnt
  v_mov_b32 v16, 0
  s_mov_b64 exec, 1
  buffer_store_dword v16, v16, s[36:39], s47 offen sc1
L_nocnt:
  s_mov_b64 exec, -1
  s_lshl_b32 s47, s52, 9
  s_lshl_b32 s48, s57, 6
  s_add_u32 s47, s47, s48
  s_add_u32 s28, s10, s47
  s_addc_u32 s29, s11, 0
  s_sub_u32 s30, 4718592, s47
  v_lshrrev_b32 v13, 2, v1
  v_and_b32 v14, 3, v1
  s_mov_b32 s47, 294912
  v_mul_lo_u32 v6, v13, s47
  v_lshl_add_u32 v6, v14, 4, v6
  s_mov_b32 s54, 0
  buffer_load_dwordx4 v[48:51], v6, s[28:31], s54 offen nt
  s_add_u32 s54, s54, 0x2000
  buffer_load_dwordx4 v[52:55], v6, s[28:31], s54 offen nt
  s_add_u32 s54, s54, 0x2000
  s_mul_i32 s47, s53, 1152
  s_add_u32 s32, s4, s47
  s_addc_u32 s33, s5, 0
  s_mov_b32 s34, 1152
  v_mul_u32_u24 v15, 72, v13
  buffer_load_dwordx4 v[192:195], v15, s[32:35], 0 offen offset:0
  buffer_load_dwordx4 v[196:199], v15, s[32:35], 0 offen offset:16
  buffer_load_dwordx4 v[200:203], v15, s[32:35], 0 offen offset:32
  buffer_load_dwordx4 v[204:207], v15, s[32:35], 0 offen offset:48
  buffer_load_dwordx2 v[208:209], v15, s[32:35], 0 offen offset:64
  buffer_load_dwordx4 v[56:59], v6, s[28:31], s54 offen nt
  s_add_u32 s54, s54, 0x2000
  buffer_load_dwordx4 v[60:63], v6, s[28:31], s54 offen nt
  s_add_u32 s54, s54, 0x2000
  buffer_load_dwordx4 v[64:67], v6, s[28:31], s54 offen nt
  s_add_u32 s54, s54, 0x2000
  buffer_load_dwordx4 v[68:71], v6, s[28:31], s54 offen nt
  s_add_u32 s54, s54, 0x2000
  buffer_load_dwordx4 v[72:75], v6, s[28:31], s54 offen nt
  s_add_u32 s54, s54, 0x2000
  buffer_load_dwordx4 v[76:79], v6, s[28:31], s54 offen nt
  s_add_u32 s54, s54, 0x2000
  buffer_load_dwordx4 v[80:83], v6, s[28:31], s54 offen nt
  s_add_u32 s54, s54, 0x2000
  buffer_load_dwordx4 v[84:87], v6, s[28:31], s54 offen nt
  s_add_u32 s54, s54, 0x2000
  buffer_load_dwordx4 v[88:91], v6, s[28:31], s54 offen nt
  s_add_u32 s54, s54, 0x2000
  buffer_load_dwordx4 v[92:95], v6, s[28:31], s54 offen nt
  s_add_u32 s54, s54, 0x2000
  buffer_load_dwordx4 v[96:99], v6, s[28:31], s54 offen nt
  s_add_u32 s54, s54, 0x2000
  buffer_load_dwordx4 v[100:103], v6, s[28:31], s54 offen nt
  s_add_u32 s54, s54, 0x2000
  buffer_load_dwordx4 v[104:107], v6, s[28:31], s54 offen nt
  s_add_u32 s54, s54, 0x2000
  buffer_load_dwordx4 v[108:111], v6, s[28:31], s54 offen nt
  s_add_u32 s54, s54, 0x2000
  buffer_load_dwordx4 v[112:115], v6, s[28:31], s54 offen nt
  s_add_u32 s54, s54, 0x2000
  buffer_load_dwordx4 v[116:119], v6, s[28:31], s54 offen nt
  s_add_u32 s54, s54, 0x2000
  buffer_load_dwordx4 v[120:123], v6, s[28:31], s54 offen nt
  s_add_u32 s54, s54, 0x2000
  buffer_load_dwordx4 v[124:127], v6, s[28:31], s54 offen nt
  s_add_u32 s54, s54, 0x2000
  buffer_load_dwordx4 v[128:131], v6, s[28:31], s54 offen nt
  s_add_u32 s54, s54, 0x2000
  buffer_load_dwordx4 v[132:135], v6, s[28:31], s54 offen nt
  s_add_u32 s54, s54, 0x2000
  buffer_load_dwordx4 v[136:139], v6, s[28:31], s54 offen nt
  s_add_u32 s54, s54, 0x2000
  buffer_load_dwordx4 v[140:143], v6, s[28:31], s54 offen nt
  s_add_u32 s54, s54, 0x2000
  buffer_load_dwordx4 v[144:147], v6, s[28:31], s54 offen nt
  s_add_u32 s54, s54, 0x2000
  buffer_load_dwordx4 v[148:151], v6, s[28:31], s54 offen nt
  s_add_u32 s54, s54, 0x2000
  buffer_load_dwordx4 v[152:155], v6, s[28:31], s54 offen nt
  s_add_u32 s54, s54, 0x2000
  buffer_load_dwordx4 v[156:159], v6, s[28:31], s54 offen nt
  s_add_u32 s54, s54, 0x2000
  buffer_load_dwordx4 v[160:163], v6, s[28:31], s54 offen nt
  s_add_u32 s54, s54, 0x2000
  buffer_load_dwordx4 v[164:167], v6, s[28:31], s54 offen nt
  s_add_u32 s54, s54, 0x2000
  buffer_load_dwordx4 v[168:171], v6, s[28:31], s54 offen nt
  s_add_u32 s54, s54, 0x2000
  buffer_load_dwordx4 v[172:175], v6, s[28:31], s54 offen nt
  s_add_u32 s54, s54, 0x2000
  buffer_load_dwordx4 v[176:179], v6, s[28:31], s54 offen nt
  s_add_u32 s54, s54, 0x2000
  buffer_load_dwordx4 v[180:183], v6, s[28:31], s54 offen nt
  s_add_u32 s54, s54, 0x2000
  buffer_load_dwordx4 v[184:187], v6, s[28:31], s54 offen nt
  s_add_u32 s54, s54, 0x2000
  buffer_load_dwordx4 v[188:191], v6, s[28:31], s54 offen nt
  s_mov_b32 s72, 0x05040100
  s_mov_b32 s73, 0x07060302
  s_waitcnt vmcnt(34)
  v_perm_b32 v32, v52, v48, s72
  v_perm_b32 v33, v52, v48, s73
  v_perm_b32 v34, v53, v49, s72
  v_perm_b32 v35, v53, v49, s73
  v_perm_b32 v36, v54, v50, s72
  v_perm_b32 v37, v54, v50, s73
  v_perm_b32 v38, v55, v51, s72
  v_perm_b32 v39, v55, v51, s73
  v_dot2_f32_bf16 v212, v32, v192, 0
  v_dot2_f32_bf16 v213, v33, v192, 0
  v_dot2_f32_bf16 v214, v34, v192, 0
  v_dot2_f32_bf16 v215, v35, v192, 0
  v_dot2_f32_bf16 v216, v36, v192, 0
  v_dot2_f32_bf16 v217, v37, v192, 0
  v_dot2_f32_bf16 v218, v38, v192, 0
  v_dot2_f32_bf16 v219, v39, v192, 0
  s_waitcnt vmcnt(32)
  v_perm_b32 v32, v60, v56, s72
  v_perm_b32 v33, v60, v56, s73
  v_perm_b32 v34, v61, v57, s72
  v_perm_b32 v35, v61, v57, s73
  v_perm_b32 v36, v62, v58, s72
  v_perm_b32 v37, v62, v58, s73
  v_perm_b32 v38, v63, v59, s72
  v_perm_b32 v39, v63, v59, s73
  v_dot2_f32_bf16 v212, v32, v193, v212
  v_dot2_f32_bf16 v213, v33, v193, v213
  v_dot2_f32_bf16 v214, v34, v193, v214
  v_dot2_f32_bf16 v215, v35, v193, v215
  v_dot2_f32_bf16 v216, v36, v193, v216
  v_dot2_f32_bf16 v217, v37, v193, v217
  v_dot2_f32_bf16 v218, v38, v193, v218
  v_dot2_f32_bf16 v219, v39, v193, v219
  s_waitcnt vmcnt(30)
  v_perm_b32 v32, v68, v64, s72
  v_perm_b32 v33, v68, v64, s73
  v_perm_b32 v34, v69, v65, s72
  v_perm_b32 v35, v69, v65, s73
  v_perm_b32 v36, v70, v66, s72
  v_perm_b32 v37, v70, v66, s73
  v_perm_b32 v38, v71, v67, s72
  v_perm_b32 v39, v71, v67, s73
  v_dot2_f32_bf16 v212, v32, v194, v212
  v_dot2_f32_bf16 v213, v33, v194, v213
  v_dot2_f32_bf16 v214, v34, v194, v214
  v_dot2_f32_bf16 v215, v35, v194, v215
  v_dot2_f32_bf16 v216, v36, v194, v216
  v_dot2_f32_bf16 v217, v37, v194, v217
  v_dot2_f32_bf16 v218, v38, v194, v218
  v_dot2_f32_bf16 v219, v39, v194, v219
  s_waitcnt vmcnt(28)
  v_perm_b32 v32, v76, v72, s72
  v_perm_b32 v33, v76, v72, s73
  v_perm_b32 v34, v77, v73, s72
  v_perm_b32 v35, v77, v73, s73
  v_perm_b32 v36, v78, v74, s72
  v_perm_b32 v37, v78, v74, s73
  v_perm_b32 v38, v79, v75, s72
  v_perm_b32 v39, v79, v75, s73
  v_dot2_f32_bf16 v212, v32, v195, v212
  v_dot2_f32_bf16 v213, v33, v195, v213
  v_dot2_f32_bf16 v214, v34, v195, v214
  v_dot2_f32_bf16 v215, v35, v195, v215
  v_dot2_f32_bf16 v216, v36, v195, v216
  v_dot2_f32_bf16 v217, v37, v195, v217
  v_dot2_f32_bf16 v218, v38, v195, v218
  v_dot2_f32_bf16 v219, v39, v195, v219
  s_waitcnt vmcnt(26)
  v_perm_b32 v32, v84, v80, s72
  v_perm_b32 v33, v84, v80, s73
  v_perm_b32 v34, v85, v81, s72
  v_perm_b32 v35, v85, v81, s73
  v_perm_b32 v36, v86, v82, s72
  v_perm_b32 v37, v86, v82, s73
  v_perm_b32 v38, v87, v83, s72
  v_perm_b32 v39, v87, v83, s73
  v_dot2_f32_bf16 v212, v32, v196, v212
  v_dot2_f32_bf16 v213, v33, v196, v213
  v_dot2_f32_bf16 v214, v34, v196, v214
  v_dot2_f32_bf16 v215, v35, v196, v215
  v_dot2_f32_bf16 v216, v36, v196, v216
  v_dot2_f32_bf16 v217, v37, v196, v217
  v_dot2_f32_bf16 v218, v38, v196, v218
  v_dot2_f32_bf16 v219, v39, v196, v219
  s_waitcnt vmcnt(24)
  v_perm_b32 v32, v92, v88, s72
  v_perm_b32 v33, v92, v88, s73
  v_perm_b32 v34, v93, v89, s72
  v_perm_b32 v35, v93, v89, s73
  v_perm_b32 v36, v94, v90, s72
  v_perm_b32 v37, v94, v90, s73
  v_perm_b32 v38, v95, v91, s72
  v_perm_b32 v39, v95, v91, s73
  v_dot2_f32_bf16 v212, v32, v197, v212
  v_dot2_f32_bf16 v213, v33, v197, v213
  v_dot2_f32_bf16 v214, v34, v197, v214
  v_dot2_f32_bf16 v215, v35, v197, v215
  v_dot2_f32_bf16 v216, v36, v197, v216
  v_dot2_f32_bf16 v217, v37, v197, v217
  v_dot2_f32_bf16 v218, v38, v197, v218
  v_dot2_f32_bf16 v219, v39, v197, v219
  s_waitcnt vmcnt(22)
  v_perm_b32 v32, v100, v96, s72
  v_perm_b32 v33, v100, v96, s73
  v_perm_b32 v34, v101, v97, s72
  v_perm_b32 v35, v101, v97, s73
  v_perm_b32 v36, v102, v98, s72
  v_perm_b32 v37, v102, v98, s73
  v_perm_b32 v38, v103, v99, s72
  v_perm_b32 v39, v103, v99, s73
  v_dot2_f32_bf16 v212, v32, v198, v212
  v_dot2_f32_bf16 v213, v33, v198, v213
  v_dot2_f32_bf16 v214, v34, v198, v214
  v_dot2_f32_bf16 v215, v35, v198, v215
  v_dot2_f32_bf16 v216, v36, v198, v216
  v_dot2_f32_bf16 v217, v37, v198, v217
  v_dot2_f32_bf16 v218, v38, v198, v218
  v_dot2_f32_bf16 v219, v39, v198, v219
  s_waitcnt vmcnt(20)
  v_perm_b32 v32, v108, v104, s72
  v_perm_b32 v33, v108, v104, s73
  v_perm_b32 v34, v109, v105, s72
  v_perm_b32 v35, v109, v105, s73
  v_perm_b32 v36, v110, v106, s72
  v_perm_b32 v37, v110, v106, s73
  v_perm_b32 v38, v111, v107, s72
  v_perm_b32 v39, v111, v107, s73
  v_dot2_f32_bf16 v212, v32, v199, v212
  v_dot2_f32_bf16 v213, v33, v199, v213
  v_dot2_f32_bf16 v214, v34, v199, v214
  v_dot2_f32_bf16 v215, v35, v199, v215
  v_dot2_f32_bf16 v216, v36, v199, v216
  v_dot2_f32_bf16 v217, v37, v199, v217
  v_dot2_f32_bf16 v218, v38, v199, v218
  v_dot2_f32_bf16 v219, v39, v199, v219
  s_waitcnt vmcnt(18)
  v_perm_b32 v32, v116, v112, s72
  v_perm_b32 v33, v116, v112, s73
  v_perm_b32 v34, v117, v113, s72
  v_perm_b32 v35, v117, v113, s73
  v_perm_b32 v36, v118, v114, s72
  v_perm_b32 v37, v118, v114, s73
  v_perm_b32 v38, v119, v115, s72
  v_perm_b32 v39, v119, v115, s73
  v_dot2_f32_bf16 v212, v32, v200, v212
  v_dot2_f32_bf16 v213, v33, v200, v213
  v_dot2_f32_bf16 v214, v34, v200, v214
  v_dot2_f32_bf16 v215, v35, v200, v215
  v_dot2_f32_bf16 v216, v36, v200, v216
  v_dot2_f32_bf16 v217, v37, v200, v217
  v_dot2_f32_bf16 v218, v38, v200, v218
  v_dot2_f32_bf16 v219, v39, v200, v219
  s_waitcnt vmcnt(16)
  v_perm_b32 v32, v124, v120, s72
  v_perm_b32 v33, v124, v120, s73
  v_perm_b32 v34, v125, v121, s72
  v_perm_b32 v35, v125, v121, s73
  v_perm_b32 v36, v126, v122, s72
  v_perm_b32 v37, v126, v122, s73
  v_perm_b32 v38, v127, v123, s72
  v_perm_b32 v39, v127, v123, s73
  v_dot2_f32_bf16 v212, v32, v201, v212
  v_dot2_f32_bf16 v213, v33, v201, v213
  v_dot2_f32_bf16 v214, v34, v201, v214
  v_dot2_f32_bf16 v215, v35, v201, v215
  v_dot2_f32_bf16 v216, v36, v201, v216
  v_dot2_f32_bf16 v217, v37, v201, v217
  v_dot2_f32_bf16 v218, v38, v201, v218
  v_dot2_f32_bf16 v219, v39, v201, v219
  s_waitcnt vmcnt(14)
  v_perm_b32 v32, v132, v128, s72
  v_perm_b32 v33, v132, v128, s73
  v_perm_b32 v34, v133, v129, s72
  v_perm_b32 v35, v133, v129, s73
  v_perm_b32 v36, v134, v130, s72
  v_perm_b32 v37, v134, v130, s73
  v_perm_b32 v38, v135, v131, s72
  v_perm_b32 v39, v135, v131, s73
  v_dot2_f32_bf16 v212, v32, v202, v212
  v_dot2_f32_bf16 v213, v33, v202, v213
  v_dot2_f32_bf16 v214, v34, v202, v214
  v_dot2_f32_bf16 v215, v35, v202, v215
  v_dot2_f32_bf16 v216, v36, v202, v216
  v_dot2_f32_bf16 v217, v37, v202, v217
  v_dot2_f32_bf16 v218, v38, v202, v218
  v_dot2_f32_bf16 v219, v39, v202, v219
  s_waitcnt vmcnt(12)
  v_perm_b32 v32, v140, v136, s72
  v_perm_b32 v33, v140, v136, s73
  v_perm_b32 v34, v141, v137, s72
  v_perm_b32 v35, v141, v137, s73
  v_perm_b32 v36, v142, v138, s72
  v_perm_b32 v37, v142, v138, s73
  v_perm_b32 v38, v143, v139, s72
  v_perm_b32 v39, v143, v139, s73
  v_dot2_f32_bf16 v212, v32, v203, v212
  v_dot2_f32_bf16 v213, v33, v203, v213
  v_dot2_f32_bf16 v214, v34, v203, v214
  v_dot2_f32_bf16 v215, v35, v203, v215
  v_dot2_f32_bf16 v216, v36, v203, v216
  v_dot2_f32_bf16 v217, v37, v203, v217
  v_dot2_f32_bf16 v218, v38, v203, v218
  v_dot2_f32_bf16 v219, v39, v203, v219
  s_waitcnt vmcnt(10)
  v_perm_b32 v32, v148, v144, s72
  v_perm_b32 v33, v148, v144, s73
  v_perm_b32 v34, v149, v145, s72
  v_perm_b32 v35, v149, v145, s73
  v_perm_b32 v36, v150, v146, s72
  v_perm_b32 v37, v150, v146, s73
  v_perm_b32 v38, v151, v147, s72
  v_perm_b32 v39, v151, v147, s73
  v_dot2_f32_bf16 v212, v32, v204, v212
  v_dot2_f32_bf16 v213, v33, v204, v213
  v_dot2_f32_bf16 v214, v34, v204, v214
  v_dot2_f32_bf16 v215, v35, v204, v215
  v_dot2_f32_bf16 v216, v36, v204, v216
  v_dot2_f32_bf16 v217, v37, v204, v217
  v_dot2_f32_bf16 v218, v38, v204, v218
  v_dot2_f32_bf16 v219, v39, v204, v219
  s_waitcnt vmcnt(8)
  v_perm_b32 v32, v156, v152, s72
  v_perm_b32 v33, v156, v152, s73
  v_perm_b32 v34, v157, v153, s72
  v_perm_b32 v35, v157, v153, s73
  v_perm_b32 v36, v158, v154, s72
  v_perm_b32 v37, v158, v154, s73
  v_perm_b32 v38, v159, v155, s72
  v_perm_b32 v39, v159, v155, s73
  v_dot2_f32_bf16 v212, v32, v205, v212
  v_dot2_f32_bf16 v213, v33, v205, v213
  v_dot2_f32_bf16 v214, v34, v205, v214
  v_dot2_f32_bf16 v215, v35, v205, v215
  v_dot2_f32_bf16 v216, v36, v205, v216
  v_dot2_f32_bf16 v217, v37, v205, v217
  v_dot2_f32_bf16 v218, v38, v205, v218
  v_dot2_f32_bf16 v219, v39, v205, v219
  s_waitcnt vmcnt(6)
  v_perm_b32 v32, v164, v160, s72
  v_perm_b32 v33, v164, v160, s73
  v_perm_b32 v34, v165, v161, s72
  v_perm_b32 v35, v165, v161, s73
  v_perm_b32 v36, v166, v162, s72
  v_perm_b32 v37, v166, v162, s73
  v_perm_b32 v38, v167, v163, s72
  v_perm_b32 v39, v167, v163, s73
  v_dot2_f32_bf16 v212, v32, v206, v212
  v_dot2_f32_bf16 v213, v33, v206, v213
  v_dot2_f32_bf16 v214, v34, v206, v214
  v_dot2_f32_bf16 v215, v35, v206, v215
  v_dot2_f32_bf16 v216, v36, v206, v216
  v_dot2_f32_bf16 v217, v37, v206, v217
  v_dot2_f32_bf16 v218, v38, v206, v218
  v_dot2_f32_bf16 v219, v39, v206, v219
  s_waitcnt vmcnt(4)
  v_perm_b32 v32, v172, v168, s72
  v_perm_b32 v33, v172, v168, s73
  v_perm_b32 v34, v173, v169, s72
  v_perm_b32 v35, v173, v169, s73
  v_perm_b32 v36, v174, v170, s72
  v_perm_b32 v37, v174, v170, s73
  v_perm_b32 v38, v175, v171, s72
  v_perm_b32 v39, v175, v171, s73
  v_dot2_f32_bf16 v212, v32, v207, v212
  v_dot2_f32_bf16 v213, v33, v207, v213
  v_dot2_f32_bf16 v214, v34, v207, v214
  v_dot2_f32_bf16 v215, v35, v207, v215
  v_dot2_f32_bf16 v216, v36, v207, v216
  v_dot2_f32_bf16 v217, v37, v207, v217
  v_dot2_f32_bf16 v218, v38, v207, v218
  v_dot2_f32_bf16 v219, v39, v207, v219
  s_waitcnt vmcnt(2)
  v_perm_b32 v32, v180, v176, s72
  v_perm_b32 v33, v180, v176, s73
  v_perm_b32 v34, v181, v177, s72
  v_perm_b32 v35, v181, v177, s73
  v_perm_b32 v36, v182, v178, s72
  v_perm_b32 v37, v182, v178, s73
  v_perm_b32 v38, v183, v179, s72
  v_perm_b32 v39, v183, v179, s73
  v_dot2_f32_bf16 v212, v32, v208, v212
  v_dot2_f32_bf16 v213, v33, v208, v213
  v_dot2_f32_bf16 v214, v34, v208, v214
  v_dot2_f32_bf16 v215, v35, v208, v215
  v_dot2_f32_bf16 v216, v36, v208, v216
  v_dot2_f32_bf16 v217, v37, v208, v217
  v_dot2_f32_bf16 v218, v38, v208, v218
  v_dot2_f32_bf16 v219, v39, v208, v219
  s_waitcnt vmcnt(0)
  v_perm_b32 v32, v188, v184, s72
  v_perm_b32 v33, v188, v184, s73
  v_perm_b32 v34, v189, v185, s72
  v_perm_b32 v35, v189, v185, s73
  v_perm_b32 v36, v190, v186, s72
  v_perm_b32 v37, v190, v186, s73
  v_perm_b32 v38, v191, v187, s72
  v_perm_b32 v39, v191, v187, s73
  v_dot2_f32_bf16 v212, v32, v209, v212
  v_dot2_f32_bf16 v213, v33, v209, v213
  v_dot2_f32_bf16 v214, v34, v209, v214
  v_dot2_f32_bf16 v215, v35, v209, v215
  v_dot2_f32_bf16 v216, v36, v209, v216
  v_dot2_f32_bf16 v217, v37, v209, v217
  v_dot2_f32_bf16 v218, v38, v209, v218
  v_dot2_f32_bf16 v219, v39, v209, v219
  s_load_dwordx2 s[74:75], s[16:17], 0
  s_nop 2
  v_add_f32_dpp v212, v212, v212 row_ror:4 row_mask:0xf bank_mask:0xf
  v_add_f32_dpp v213, v213, v213 row_ror:4 row_mask:0xf bank_mask:0xf
  v_add_f32_dpp v214, v214, v214 row_ror:4 row_mask:0xf bank_mask:0xf
  v_add_f32_dpp v215, v215, v215 row_ror:4 row_mask:0xf bank_mask:0xf
  v_add_f32_dpp v216, v216, v216 row_ror:4 row_mask:0xf bank_mask:0xf
  v_add_f32_dpp v217, v217, v217 row_ror:4 row_mask:0xf bank_mask:0xf
  v_add_f32_dpp v218, v218, v218 row_ror:4 row_mask:0xf bank_mask:0xf
  v_add_f32_dpp v219, v219, v219 row_ror:4 row_mask:0xf bank_mask:0xf
  v_add_f32_dpp v212, v212, v212 row_ror:8 row_mask:0xf bank_mask:0xf
  v_add_f32_dpp v213, v213, v213 row_ror:8 row_mask:0xf bank_mask:0xf
  v_add_f32_dpp v214, v214, v214 row_ror:8 row_mask:0xf bank_mask:0xf
  v_add_f32_dpp v215, v215, v215 row_ror:8 row_mask:0xf bank_mask:0xf
  v_add_f32_dpp v216, v216, v216 row_ror:8 row_mask:0xf bank_mask:0xf
  v_add_f32_dpp v217, v217, v217 row_ror:8 row_mask:0xf bank_mask:0xf
  v_add_f32_dpp v218, v218, v218 row_ror:8 row_mask:0xf bank_mask:0xf
  v_add_f32_dpp v219, v219, v219 row_ror:8 row_mask:0xf bank_mask:0xf
  v_mov_b32 v32, v212
  v_mov_b32 v33, v213
  v_mov_b32 v34, v214
  v_mov_b32 v35, v215
  v_mov_b32 v36, v216
  v_mov_b32 v37, v217
  v_mov_b32 v38, v218
  v_mov_b32 v39, v219
  v_permlane16_swap_b32 v212, v32
  v_permlane16_swap_b32 v213, v33
  v_permlane16_swap_b32 v214, v34
  v_permlane16_swap_b32 v215, v35
  v_permlane16_swap_b32 v216, v36
  v_permlane16_swap_b32 v217, v37
  v_permlane16_swap_b32 v218, v38
  v_permlane16_swap_b32 v219, v39
  v_add_f32 v212, v212, v32
  v_add_f32 v213, v213, v33
  v_add_f32 v214, v214, v34
  v_add_f32 v215, v215, v35
  v_add_f32 v216, v216, v36
  v_add_f32 v217, v217, v37
  v_add_f32 v218, v218, v38
  v_add_f32 v219, v219, v39
  v_mov_b32 v32, v212
  v_mov_b32 v33, v213
  v_mov_b32 v34, v214
  v_mov_b32 v35, v215
  v_mov_b32 v36, v216
  v_mov_b32 v37, v217
  v_mov_b32 v38, v218
  v_mov_b32 v39, v219
  v_permlane32_swap_b32 v212, v32
  v_permlane32_swap_b32 v213, v33
  v_permlane32_swap_b32 v214, v34
  v_permlane32_swap_b32 v215, v35
  v_permlane32_swap_b32 v216, v36
  v_permlane32_swap_b32 v217, v37
  v_permlane32_swap_b32 v218, v38
  v_permlane32_swap_b32 v219, v39
  v_add_f32 v212, v212, v32
  v_add_f32 v213, v213, v33
  v_add_f32 v214, v214, v34
  v_add_f32 v215, v215, v35
  v_add_f32 v216, v216, v36
  v_add_f32 v217, v217, v37
  v_add_f32 v218, v218, v38
  v_add_f32 v219, v219, v39
  v_cvt_pk_bf16_f32 v32, v212, v212
  v_cvt_pk_bf16_f32 v33, v213, v213
  v_cvt_pk_bf16_f32 v34, v214, v214
  v_cvt_pk_bf16_f32 v35, v215, v215
  v_cvt_pk_bf16_f32 v36, v216, v216
  v_cvt_pk_bf16_f32 v37, v217, v217
  v_cvt_pk_bf16_f32 v38, v218, v218
  v_cvt_pk_bf16_f32 v39, v219, v219
  s_waitcnt lgkmcnt(0)
  s_cmp_lg_u32 s75, 0
  s_cbranch_scc1 L_tagok
  s_mov_b32 s32, s16
  s_mov_b32 s33, s17
  s_mov_b32 s34, 256
  v_mov_b32 v16, 0
  s_mov_b64 exec, 1
L_tagpoll:
  buffer_load_dwordx2 v[220:221], v16, s[32:35], 0 offen sc1
  s_waitcnt vmcnt(0)
  v_readfirstlane_b32 s74, v220
  v_readfirstlane_b32 s75, v221
  s_cmp_lg_u32 s75, 0
  s_cbranch_scc1 L_tagok2
  s_sleep 16
  s_sub_u32 s58, s58, 1
  s_cmp_lg_u32 s58, 0
  s_cbranch_scc1 L_tagpoll
L_tagok2:
  s_mov_b64 exec, -1
L_tagok:
  s_lshl_b32 s76, s74, 16
  s_lshr_b32 s77, s74, 16
  s_lshl_b32 s75, s75, 16
  s_or_b32 s77, s77, s75
  v_mov_b32 v15, s76
  s_mov_b32 s47, 0x07060100
  v_bfe_u32 v14, v1, 2, 2
  v_cmp_eq_u32 vcc, 1, v14
  s_nop 1
  v_cndmask_b32 v32, v32, v34, vcc
  v_cndmask_b32 v33, v33, v35, vcc
  v_cmp_eq_u32 vcc, 2, v14
  s_nop 1
  v_cndmask_b32 v32, v32, v36, vcc
  v_cndmask_b32 v33, v33, v37, vcc
  v_cmp_eq_u32 vcc, 3, v14
  s_nop 1
  v_cndmask_b32 v32, v32, v38, vcc
  v_cndmask_b32 v33, v33, v39, vcc
  v_perm_b32 v224, v15, v32, s47
  v_mov_b32 v225, s77
  v_perm_b32 v226, v15, v33, s47
  v_mov_b32 v227, s77
  s_lshl_b32 s54, s41, 11
  s_add_u32 s54, s54, 524288
  s_lshr_b32 s47, s43, 3
  s_add_u32 s47, s47, 524288
  v_and_b32 v13, 3, v1
  v_lshlrev_b32 v13, 6, v13
  v_lshl_add_u32 v13, v14, 4, v13
  s_mov_b64 exec, 0xffff
  buffer_store_dwordx4 v[224:227], v13, s[36:39], s47 offen sc1
  s_mov_b64 exec, -1
  v_lshlrev_b32 v13, 5, v1
  s_add_u32 s60, s18, s54
  s_addc_u32 s61, s19, 0
  s_mov_b32 s59, 64
L_spoll:
  s_mov_b32 s49, 0
  s_load_dwordx2 s[44:45], s[60:61], 120 glc
  s_load_dwordx2 s[62:63], s[60:61], 248 glc
  s_load_dwordx2 s[64:65], s[60:61], 376 glc
  s_load_dwordx2 s[66:67], s[60:61], 504 glc
  s_load_dwordx2 s[68:69], s[60:61], 632 glc
  s_load_dwordx2 s[78:79], s[60:61], 760 glc
  s_load_dwordx2 s[96:97], s[60:61], 888 glc
  s_load_dwordx2 s[98:99], s[60:61], 1016 glc
  s_waitcnt lgkmcnt(0)
  s_xor_b32 s45, s45, s77
  s_or_b32 s49, s49, s45
  s_xor_b32 s63, s63, s77
  s_or_b32 s49, s49, s63
  s_xor_b32 s65, s65, s77
  s_or_b32 s49, s49, s65
  s_xor_b32 s67, s67, s77
  s_or_b32 s49, s49, s67
  s_xor_b32 s69, s69, s77
  s_or_b32 s49, s49, s69
  s_xor_b32 s79, s79, s77
  s_or_b32 s49, s49, s79
  s_xor_b32 s97, s97, s77
  s_or_b32 s49, s49, s97
  s_xor_b32 s99, s99, s77
  s_or_b32 s49, s49, s99
  s_load_dwordx2 s[44:45], s[60:61], 1144 glc
  s_load_dwordx2 s[62:63], s[60:61], 1272 glc
  s_load_dwordx2 s[64:65], s[60:61], 1400 glc
  s_load_dwordx2 s[66:67], s[60:61], 1528 glc
  s_load_dwordx2 s[68:69], s[60:61], 1656 glc
  s_load_dwordx2 s[78:79], s[60:61], 1784 glc
  s_load_dwordx2 s[96:97], s[60:61], 1912 glc
  s_load_dwordx2 s[98:99], s[60:61], 2040 glc
  s_waitcnt lgkmcnt(0)
  s_xor_b32 s45, s45, s77
  s_or_b32 s49, s49, s45
  s_xor_b32 s63, s63, s77
  s_or_b32 s49, s49, s63
  s_xor_b32 s65, s65, s77
  s_or_b32 s49, s49, s65
  s_xor_b32 s67, s67, s77
  s_or_b32 s49, s49, s67
  s_xor_b32 s69, s69, s77
  s_or_b32 s49, s49, s69
  s_xor_b32 s79, s79, s77
  s_or_b32 s49, s49, s79
  s_xor_b32 s97, s97, s77
  s_or_b32 s49, s49, s97
  s_xor_b32 s99, s99, s77
  s_or_b32 s49, s49, s99
  s_cmp_eq_u32 s49, 0
  s_cbranch_scc1 L_pollq
  s_sub_u32 s59, s59, 1
  s_cmp_lg_u32 s59, 0
  s_cbranch_scc1 L_spoll
L_pollq:
  buffer_load_dwordx4 v[48:51], v13, s[36:39], s54 offen sc1
  buffer_load_dwordx4 v[52:55], v13, s[36:39], s54 offen offset:16 sc1
  s_waitcnt vmcnt(0)
  v_xor_b32 v56, s76, v48
  v_xor_b32 v57, s77, v49
  v_xor_b32 v58, s76, v50
  v_xor_b32 v59, s77, v51
  v_xor_b32 v60, s76, v52
  v_xor_b32 v61, s77, v53
  v_xor_b32 v62, s76, v54
  v_xor_b32 v63, s77, v55
  v_or3_b32 v14, v56, v58, v60
  v_or_b32 v14, v14, v62
  v_lshrrev_b32 v14, 16, v14
  v_or3_b32 v14, v14, v57, v59
  v_or3_b32 v14, v14, v61, v63
  v_cmp_ne_u32 vcc, 0, v14
  s_cbranch_vccz L_pollq_done
  s_sub_u32 s58, s58, 1
  s_cmp_lg_u32 s58, 0
  s_cbranch_scc1 L_pollq
L_pollq_done:
  v_perm_b32 v56, v50, v48, s72
  v_perm_b32 v57, v54, v52, s72
  v_lshlrev_b32 v13, 3, v1
  v_add_u32 v13, 159744, v13
  ds_write_b64 v13, v[56:57]
  s_waitcnt lgkmcnt(0)
  v_mov_b32 v14, 1
  ds_write_b32 v26, v14 offset:16
  s_mul_i32 s47, s52, 294912
  s_mul_i32 s48, s57, 144
  s_add_u32 s47, s47, s48
  s_add_u32 s28, s12, s47
  s_addc_u32 s29, s13, 0
  s_sub_u32 s30, 4718592, s47
  s_lshr_b32 s47, s40, 2
  s_lshl_b32 s47, s47, 7
  s_and_b32 s48, s40, 3
  s_lshl_b32 s48, s48, 1
  s_add_u32 s47, s47, s48
  s_mul_i32 s54, s47, 1152
  v_min_u32 v15, 8, v3
  v_lshlrev_b32 v15, 4, v15
  v_mul_u32_u24 v16, 36864, v2
  v_add_u32 v6, v15, v16
  buffer_load_dwordx4 v[204:207], v6, s[28:31], s54 offen offset:0 nt
  buffer_load_dwordx4 v[208:211], v6, s[28:31], s54 offen offset:1152 nt
  s_add_u32 s54, s54, 9216
  buffer_load_dwordx4 v[212:215], v6, s[28:31], s54 offen offset:0 nt
  buffer_load_dwordx4 v[216:219], v6, s[28:31], s54 offen offset:1152 nt
  s_add_u32 s54, s54, 9216
  buffer_load_dwordx4 v[220:223], v6, s[28:31], s54 offen offset:0 nt
  buffer_load_dwordx4 v[224:227], v6, s[28:31], s54 offen offset:1152 nt
  s_add_u32 s54, s54, 9216
  buffer_load_dwordx4 v[228:231], v6, s[28:31], s54 offen offset:0 nt
  buffer_load_dwordx4 v[232:235], v6, s[28:31], s54 offen offset:1152 nt
  v_and_b32 v13, 1, v3
  v_bfe_u32 v14, v3, 1, 2
  v_cmp_eq_u32 vcc, 1, v13
  v_mov_b32 v15, 0x0c0c0100
  v_mov_b32 v16, 0x01000c0c
  v_cndmask_b32 v15, v15, v16, vcc
  v_mov_b32 v13, 0x0c0c0302
  v_mov_b32 v16, 0x03020c0c
  v_cndmask_b32 v16, v13, v16, vcc
  v_mov_b32 v13, 0x0c0c0c0c
  v_cmp_eq_u32 vcc, 0, v14
  s_nop 1
  v_cndmask_b32 v18, v13, v15, vcc
  v_cndmask_b32 v19, v13, v16, vcc
  v_cmp_eq_u32 vcc, 1, v14
  s_nop 1
  v_cndmask_b32 v20, v13, v15, vcc
  v_cndmask_b32 v21, v13, v16, vcc
  v_cmp_eq_u32 vcc, 2, v14
  s_nop 1
  v_cndmask_b32 v22, v13, v15, vcc
  v_cndmask_b32 v23, v13, v16, vcc
  v_cmp_eq_u32 vcc, 3, v14
  s_nop 1
  v_cndmask_b32 v24, v13, v15, vcc
  v_cndmask_b32 v25, v13, v16, vcc
  v_mov_b32 v28, 0
  v_mov_b32 v29, 0
  v_mov_b32 v30, 0
  v_mov_b32 v31, 0
  s_lshl_b32 s47, s41, 12
  s_add_u32 s47, s47, 589824
  s_add_u32 s60, s18, s47
  s_addc_u32 s61, s19, 0
L_sv_wait0:
  ds_read_b32 v15, v26
  s_waitcnt lgkmcnt(0)
  v_readfirstlane_b32 s47, v15
  s_cmp_ge_i32 s47, 100
  s_cbranch_scc1 L_sv_go
  s_sleep 8
  s_sub_u32 s58, s58, 1
  s_cmp_lg_u32 s58, 0
  s_cbranch_scc1 L_sv_wait0
L_sv_go:
  s_lshl_b32 s47, s53, 15
  s_lshl_b32 s48, s57, 8
  s_add_u32 s47, s47, s48
  v_lshlrev_b32 v13, 11, v3
  v_add_u32 v13, s47, v13
  s_lshl_b32 s47, s56, 11
  v_and_b32 v14, 7, v3
  v_lshlrev_b32 v14, 8, v14
  v_add_u32 v14, s47, v14
  v_cmp_gt_u32 vcc, 16, v1
  s_mov_b32 s47, 524288
  s_nop 0
  v_cndmask_b32 v8, v14, v13, vcc
L_hdr:
  buffer_load_dwordx2 v[42:43], v8, s[36:39], s47 offen sc1
  s_waitcnt vmcnt(0)
  v_xor_b32 v15, s76, v42
  v_lshrrev_b32 v15, 16, v15
  v_xor_b32 v16, s77, v43
  v_or_b32 v15, v15, v16
  v_cmp_ne_u32 vcc, 0, v15
  s_cbranch_vccz L_hdr_ok
  s_sleep 16
  s_sub_u32 s58, s58, 1
  s_cmp_lg_u32 s58, 0
  s_cbranch_scc1 L_hdr
L_hdr_ok:
L_sv_wait1:
  ds_read_b32 v15, v26
  s_waitcnt lgkmcnt(0)
  v_readfirstlane_b32 s47, v15
  s_cmp_ge_i32 s47, 230
  s_cbranch_scc1 L_sv_go1
  s_sleep 8
  s_sub_u32 s58, s58, 1
  s_cmp_lg_u32 s58, 0
  s_cbranch_scc1 L_sv_wait1
L_sv_go1:
  s_mov_b32 s62, 0
L_sv_loop:
  s_mov_b32 s63, 1
  s_atomic_add s63, s[60:61], 0 glc
  s_add_u32 s62, s62, 1
  s_waitcnt lgkmcnt(0)
  s_min_u32 s63, s63, 0xffff
  s_lshl_b32 s47, s62, 16
  s_or_b32 s47, s47, s63
  v_mov_b32 v15, s47
  ds_write_b32 v26, v15 offset:12
  s_cmp_ge_u32 s63, 64
  s_cbranch_scc1 L_exit
L_sv_wait:
  ds_read_b32 v15, v26 offset:8
  s_waitcnt lgkmcnt(0)
  v_readfirstlane_b32 s47, v15
  s_cmp_eq_u32 s47, s62
  s_cbranch_scc1 L_sv_loop
  s_sleep 1
  s_sub_u32 s58, s58, 1
  s_cmp_lg_u32 s58, 0
  s_cbranch_scc1 L_sv_wait
  s_branch L_exit
L_cons:
  s_sub_u32 s62, s40, 2
  s_mov_b32 s63, s62
  v_and_b32 v13, 1, v3
  v_bfe_u32 v14, v3, 1, 2
  v_cmp_eq_u32 vcc, 1, v13
  v_mov_b32 v15, 0x0c0c0100
  v_mov_b32 v16, 0x01000c0c
  v_cndmask_b32 v15, v15, v16, vcc
  v_mov_b32 v13, 0x0c0c0302
  v_mov_b32 v16, 0x03020c0c
  v_cndmask_b32 v16, v13, v16, vcc
  v_mov_b32 v13, 0x0c0c0c0c
  v_cmp_eq_u32 vcc, 0, v14
  s_nop 1
  v_cndmask_b32 v18, v13, v15, vcc
  v_cndmask_b32 v19, v13, v16, vcc
  v_cmp_eq_u32 vcc, 1, v14
  s_nop 1
  v_cndmask_b32 v20, v13, v15, vcc
  v_cndmask_b32 v21, v13, v16, vcc
  v_cmp_eq_u32 vcc, 2, v14
  s_nop 1
  v_cndmask_b32 v22, v13, v15, vcc
  v_cndmask_b32 v23, v13, v16, vcc
  v_cmp_eq_u32 vcc, 3, v14
  s_nop 1
  v_cndmask_b32 v24, v13, v15, vcc
  v_cndmask_b32 v25, v13, v16, vcc
  v_mov_b32 v28, 0
  v_mov_b32 v29, 0
  v_mov_b32 v30, 0
  v_mov_b32 v31, 0
  s_mov_b32 s46, 0x3e0293ee
  s_lshl_b32 s47, s63, 14
  v_add_u32 v40, s47, v5
  s_lshl_b32 s48, s62, 1
  s_add_u32 s48, s48, 2
L_lspinA:
  ds_read_b64 v[42:43], v26
  s_waitcnt lgkmcnt(0)
  v_readfirstlane_b32 s47, v42
  v_readfirstlane_b32 s49, v43
  s_sub_u32 s49, s49, 1
  s_cmp_ge_i32 s47, s48
  s_cbranch_scc1 L_lokA
  s_cmp_gt_u32 s62, s49
  s_cbranch_scc1 L_exit
  s_sleep 1
  s_sub_u32 s58, s58, 1
  s_cmp_lg_u32 s58, 0
  s_cbranch_scc1 L_lspinA
L_lokA:
  ds_read_b128 v[112:115], v40 offset:0
  ds_read_b128 v[116:119], v40 offset:1024
  ds_read_b128 v[120:123], v40 offset:2048
  ds_read_b128 v[124:127], v40 offset:3072
  ds_read_b128 v[128:131], v40 offset:4096
  ds_read_b128 v[132:135], v40 offset:5120
  ds_read_b128 v[136:139], v40 offset:6144
  ds_read_b128 v[140:143], v40 offset:7168
  ds_read_b128 v[144:147], v40 offset:8192
  ds_read_b128 v[148:151], v40 offset:9216
  ds_read_b128 v[152:155], v40 offset:10240
  ds_read_b128 v[156:159], v40 offset:11264
  ds_read_b128 v[160:163], v40 offset:12288
  ds_read_b128 v[164:167], v40 offset:13312
  ds_read_b128 v[168:171], v40 offset:14336
  ds_read_b128 v[172:175], v40 offset:15360
  s_lshl_b32 s47, s63, 2
  s_add_u32 s47, s47, 160416
  v_mov_b32 v16, s47
  s_add_u32 s48, s62, 1
  v_mov_b32 v15, s48
  s_waitcnt lgkmcnt(0)
  ds_write_b32 v16, v15
  s_add_u32 s62, s62, 6
  s_add_u32 s63, s63, 6
  s_sub_u32 s47, s63, 9
  s_cmp_ge_u32 s63, 9
  s_cselect_b32 s63, s47, s63
  s_lshl_b32 s47, s63, 14
  v_add_u32 v40, s47, v5
  s_lshl_b32 s48, s62, 1
  s_add_u32 s48, s48, 2
L_lspinA2:
  ds_read_b64 v[42:43], v26
  s_waitcnt lgkmcnt(0)
  v_readfirstlane_b32 s47, v42
  v_readfirstlane_b32 s49, v43
  s_sub_u32 s49, s49, 1
  s_cmp_ge_i32 s47, s48
  s_cbranch_scc1 L_lokA2
  s_cmp_gt_u32 s62, s49
  s_cbranch_scc1 L_exit
  s_sleep 1
  s_sub_u32 s58, s58, 1
  s_cmp_lg_u32 s58, 0
  s_cbranch_scc1 L_lspinA2
L_lokA2:
  ds_read_b128 v[48:51], v40 offset:0
  ds_read_b128 v[52:55], v40 offset:1024
  ds_read_b128 v[56:59], v40 offset:2048
  ds_read_b128 v[60:63], v40 offset:3072
  ds_read_b128 v[64:67], v40 offset:4096
  ds_read_b128 v[68:71], v40 offset:5120
  ds_read_b128 v[72:75], v40 offset:6144
  ds_read_b128 v[76:79], v40 offset:7168
  ds_read_b128 v[80:83], v40 offset:8192
  ds_read_b128 v[84:87], v40 offset:9216
  ds_read_b128 v[88:91], v40 offset:10240
  ds_read_b128 v[92:95], v40 offset:11264
  ds_read_b128 v[96:99], v40 offset:12288
  ds_read_b128 v[100:103], v40 offset:13312
  ds_read_b128 v[104:107], v40 offset:14336
  ds_read_b128 v[108:111], v40 offset:15360
  s_lshl_b32 s47, s63, 2
  s_add_u32 s47, s47, 160416
  v_mov_b32 v16, s47
  s_add_u32 s48, s62, 1
  v_mov_b32 v15, s48
  s_waitcnt lgkmcnt(0)
  ds_write_b32 v16, v15
L_qspin:
  ds_read_b32 v15, v26 offset:16
  s_waitcnt lgkmcnt(0)
  v_readfirstlane_b32 s47, v15
  s_cmp_lg_u32 s47, 0
  s_cbranch_scc1 L_qok
  s_sleep 1
  s_sub_u32 s58, s58, 1
  s_cmp_lg_u32 s58, 0
  s_cbranch_scc1 L_qspin
L_qok:
  v_lshrrev_b32 v13, 3, v3
  v_lshlrev_b32 v13, 8, v13
  v_lshl_add_u32 v13, v2, 4, v13
  v_add_u32 v13, 159744, v13
  ds_read_b128 v[176:179], v13 offset:0
  ds_read_b128 v[180:183], v13 offset:64
  ds_read_b128 v[184:187], v13 offset:128
  ds_read_b128 v[188:191], v13 offset:192
  s_mov_b32 s64, 0
  s_lshl_b32 s65, s40, 1
  s_mov_b32 s70, 0
  s_waitcnt lgkmcnt(0)
  v_mfma_f32_16x16x32_bf16 v[192:195], v[112:115], v[176:179], 0
  v_mfma_f32_16x16x32_bf16 v[196:199], v[128:131], v[176:179], 0
  v_mfma_f32_16x16x32_bf16 v[192:195], v[116:119], v[180:183], v[192:195]
  v_mfma_f32_16x16x32_bf16 v[196:199], v[132:135], v[180:183], v[196:199]
  v_mfma_f32_16x16x32_bf16 v[192:195], v[120:123], v[184:187], v[192:195]
  v_mfma_f32_16x16x32_bf16 v[196:199], v[136:139], v[184:187], v[196:199]
  v_mfma_f32_16x16x32_bf16 v[192:195], v[124:127], v[188:191], v[192:195]
  v_mfma_f32_16x16x32_bf16 v[196:199], v[140:143], v[188:191], v[196:199]
  s_nop 7
  s_nop 0
  v_max3_f32 v13, v192, v193, v194
  v_max3_f32 v14, v195, v196, v197
  v_max3_f32 v13, v13, v198, v199
  v_max_f32 v13, v13, v14
  v_cmp_gt_f32 vcc, v13, v10
  s_cbranch_vccz L_fastP
  v_mov_b32 v14, v13
  s_nop 1
  v_permlane32_swap_b32 v13, v14
  v_max_f32 v13, v13, v14
  v_mov_b32 v14, v13
  s_nop 1
  v_permlane16_swap_b32 v13, v14
  v_max3_f32 v10, v13, v14, v10
  v_mul_f32 v13, s46, v10
  v_sub_f32 v14, v11, v13
  v_mov_b32 v11, v13
  v_exp_f32 v14, v14
  s_nop 0
  v_mul_f32 v12, v12, v14
  v_mul_f32 v28, v28, v14
  v_mul_f32 v29, v29, v14
  v_mul_f32 v30, v30, v14
  v_mul_f32 v31, v31, v14
L_fastP:
  v_fma_f32 v192, v192, s46, -v11
  v_fma_f32 v193, v193, s46, -v11
  v_fma_f32 v194, v194, s46, -v11
  v_fma_f32 v195, v195, s46, -v11
  v_fma_f32 v196, v196, s46, -v11
  v_fma_f32 v197, v197, s46, -v11
  v_fma_f32 v198, v198, s46, -v11
  v_fma_f32 v199, v199, s46, -v11
  v_exp_f32 v192, v192
  v_exp_f32 v193, v193
  v_exp_f32 v194, v194
  v_exp_f32 v195, v195
  v_exp_f32 v196, v196
  v_exp_f32 v197, v197
  v_exp_f32 v198, v198
  v_exp_f32 v199, v199
  s_nop 0
  v_cvt_pk_bf16_f32 v200, v192, v193
  v_cvt_pk_bf16_f32 v201, v194, v195
  v_cvt_pk_bf16_f32 v202, v196, v197
  v_cvt_pk_bf16_f32 v203, v198, v199
  v_perm_b32 v32, v200, v200, v18
  v_perm_b32 v33, v200, v200, v20
  v_perm_b32 v34, v200, v200, v22
  v_perm_b32 v35, v200, v200, v24
  v_perm_b32 v36, v200, v200, v19
  v_perm_b32 v37, v200, v200, v21
  v_perm_b32 v38, v200, v200, v23
  v_perm_b32 v39, v200, v200, v25
  v_mfma_f32_16x16x32_bf16 v[28:31], v[144:147], v[32:35], v[28:31]
  v_perm_b32 v32, v201, v201, v18
  v_perm_b32 v33, v201, v201, v20
  v_perm_b32 v34, v201, v201, v22
  v_perm_b32 v35, v201, v201, v24
  v_mfma_f32_16x16x32_bf16 v[28:31], v[148:151], v[36:39], v[28:31]
  v_perm_b32 v36, v201, v201, v19
  v_perm_b32 v37, v201, v201, v21
  v_perm_b32 v38, v201, v201, v23
  v_perm_b32 v39, v201, v201, v25
  v_mfma_f32_16x16x32_bf16 v[28:31], v[152:155], v[32:35], v[28:31]
  v_perm_b32 v32, v202, v202, v18
  v_perm_b32 v33, v202, v202, v20
  v_perm_b32 v34, v202, v202, v22
  v_perm_b32 v35, v202, v202, v24
  v_mfma_f32_16x16x32_bf16 v[28:31], v[156:159], v[36:39], v[28:31]
  v_perm_b32 v36, v202, v202, v19
  v_perm_b32 v37, v202, v202, v21
  v_perm_b32 v38, v202, v202, v23
  v_perm_b32 v39, v202, v202, v25
  v_mfma_f32_16x16x32_bf16 v[28:31], v[160:163], v[32:35], v[28:31]
  v_perm_b32 v32, v203, v203, v18
  v_perm_b32 v33, v203, v203, v20
  v_perm_b32 v34, v203, v203, v22
  v_perm_b32 v35, v203, v203, v24
  v_mfma_f32_16x16x32_bf16 v[28:31], v[164:167], v[36:39], v[28:31]
  v_perm_b32 v36, v203, v203, v19
  v_perm_b32 v37, v203, v203, v21
  v_perm_b32 v38, v203, v203, v23
  v_perm_b32 v39, v203, v203, v25
  v_mfma_f32_16x16x32_bf16 v[28:31], v[168:171], v[32:35], v[28:31]
  v_add_f32 v13, v192, v193
  v_add_f32 v14, v194, v195
  v_add_f32 v15, v196, v197
  v_add_f32 v16, v198, v199
  v_mfma_f32_16x16x32_bf16 v[28:31], v[172:175], v[36:39], v[28:31]
  v_add_f32 v13, v13, v14
  v_add_f32 v15, v15, v16
  v_add_f32 v12, v12, v13
  v_add_f32 v12, v12, v15
L_loop:
  v_mfma_f32_16x16x32_bf16 v[192:195], v[48:51], v[176:179], 0
  v_mfma_f32_16x16x32_bf16 v[196:199], v[64:67], v[176:179], 0
  v_mfma_f32_16x16x32_bf16 v[192:195], v[52:55], v[180:183], v[192:195]
  v_mfma_f32_16x16x32_bf16 v[196:199], v[68:71], v[180:183], v[196:199]
  v_mfma_f32_16x16x32_bf16 v[192:195], v[56:59], v[184:187], v[192:195]
  v_mfma_f32_16x16x32_bf16 v[196:199], v[72:75], v[184:187], v[196:199]
  v_mfma_f32_16x16x32_bf16 v[192:195], v[60:63], v[188:191], v[192:195]
  v_mfma_f32_16x16x32_bf16 v[196:199], v[76:79], v[188:191], v[196:199]
  s_add_u32 s62, s62, 6
  s_add_u32 s63, s63, 6
  s_sub_u32 s47, s63, 9
  s_cmp_ge_u32 s63, 9
  s_cselect_b32 s63, s47, s63
  s_nop 3
  v_max3_f32 v13, v192, v193, v194
  v_max3_f32 v14, v195, v196, v197
  v_max3_f32 v13, v13, v198, v199
  v_max_f32 v13, v13, v14
  v_cmp_gt_f32 vcc, v13, v10
  s_cbranch_vccz L_fastM
  v_mov_b32 v14, v13
  s_nop 1
  v_permlane32_swap_b32 v13, v14
  v_max_f32 v13, v13, v14
  v_mov_b32 v14, v13
  s_nop 1
  v_permlane16_swap_b32 v13, v14
  v_max3_f32 v10, v13, v14, v10
  v_mul_f32 v13, s46, v10
  v_sub_f32 v14, v11, v13
  v_mov_b32 v11, v13
  v_exp_f32 v14, v14
  s_nop 0
  v_mul_f32 v12, v12, v14
  v_mul_f32 v28, v28, v14
  v_mul_f32 v29, v29, v14
  v_mul_f32 v30, v30, v14
  v_mul_f32 v31, v31, v14
L_fastM:
  v_fma_f32 v192, v192, s46, -v11
  v_fma_f32 v193, v193, s46, -v11
  v_fma_f32 v194, v194, s46, -v11
  v_fma_f32 v195, v195, s46, -v11
  v_fma_f32 v196, v196, s46, -v11
  v_fma_f32 v197, v197, s46, -v11
  v_fma_f32 v198, v198, s46, -v11
  v_fma_f32 v199, v199, s46, -v11
  v_exp_f32 v192, v192
  v_exp_f32 v193, v193
  v_exp_f32 v194, v194
  v_exp_f32 v195, v195
  v_exp_f32 v196, v196
  v_exp_f32 v197, v197
  v_exp_f32 v198, v198
  v_exp_f32 v199, v199
  s_nop 0
  v_cvt_pk_bf16_f32 v200, v192, v193
  v_cvt_pk_bf16_f32 v201, v194, v195
  v_cvt_pk_bf16_f32 v202, v196, v197
  v_cvt_pk_bf16_f32 v203, v198, v199
  v_perm_b32 v32, v200, v200, v18
  v_perm_b32 v33, v200, v200, v20
  v_perm_b32 v34, v200, v200, v22
  v_perm_b32 v35, v200, v200, v24
  v_perm_b32 v36, v200, v200, v19
  v_perm_b32 v37, v200, v200, v21
  v_perm_b32 v38, v200, v200, v23
  v_perm_b32 v39, v200, v200, v25
  s_cmp_eq_u32 s70, 0
  s_cbranch_scc1 L_vdoneM
  s_cmp_ge_i32 s66, s69
  s_cbranch_scc1 L_vokM
L_vspinM:
  ds_read_b64 v[42:43], v26
  s_waitcnt lgkmcnt(0)
  v_readfirstlane_b32 s66, v42
  v_readfirstlane_b32 s49, v43
  s_sub_u32 s49, s49, 1
  s_cmp_ge_i32 s66, s69
  s_cbranch_scc1 L_vokM
  s_sub_u32 s58, s58, 1
  s_cmp_lg_u32 s58, 0
  s_cbranch_scc1 L_vspinM
L_vokM:
  ds_read_b128 v[80:83], v40 offset:8192
  ds_read_b128 v[84:87], v40 offset:9216
  ds_read_b128 v[88:91], v40 offset:10240
  ds_read_b128 v[92:95], v40 offset:11264
  ds_read_b128 v[96:99], v40 offset:12288
  ds_read_b128 v[100:103], v40 offset:13312
  ds_read_b128 v[104:107], v40 offset:14336
  ds_read_b128 v[108:111], v40 offset:15360
  v_mov_b32 v42, s67
  v_mov_b32 v43, s68
  s_waitcnt lgkmcnt(0)
  ds_write_b32 v42, v43
L_vdoneM:
  v_mfma_f32_16x16x32_bf16 v[28:31], v[80:83], v[32:35], v[28:31]
  v_perm_b32 v32, v201, v201, v18
  v_perm_b32 v33, v201, v201, v20
  v_perm_b32 v34, v201, v201, v22
  v_perm_b32 v35, v201, v201, v24
  v_mfma_f32_16x16x32_bf16 v[28:31], v[84:87], v[36:39], v[28:31]
  v_perm_b32 v36, v201, v201, v19
  v_perm_b32 v37, v201, v201, v21
  v_perm_b32 v38, v201, v201, v23
  v_perm_b32 v39, v201, v201, v25
  v_mfma_f32_16x16x32_bf16 v[28:31], v[88:91], v[32:35], v[28:31]
  v_perm_b32 v32, v202, v202, v18
  v_perm_b32 v33, v202, v202, v20
  v_perm_b32 v34, v202, v202, v22
  v_perm_b32 v35, v202, v202, v24
  v_mfma_f32_16x16x32_bf16 v[28:31], v[92:95], v[36:39], v[28:31]
  v_perm_b32 v36, v202, v202, v19
  v_perm_b32 v37, v202, v202, v21
  v_perm_b32 v38, v202, v202, v23
  v_perm_b32 v39, v202, v202, v25
  v_mfma_f32_16x16x32_bf16 v[28:31], v[96:99], v[32:35], v[28:31]
  v_perm_b32 v32, v203, v203, v18
  v_perm_b32 v33, v203, v203, v20
  v_perm_b32 v34, v203, v203, v22
  v_perm_b32 v35, v203, v203, v24
  v_mfma_f32_16x16x32_bf16 v[28:31], v[100:103], v[36:39], v[28:31]
  v_perm_b32 v36, v203, v203, v19
  v_perm_b32 v37, v203, v203, v21
  v_perm_b32 v38, v203, v203, v23
  v_perm_b32 v39, v203, v203, v25
  v_mfma_f32_16x16x32_bf16 v[28:31], v[104:107], v[32:35], v[28:31]
  v_add_f32 v13, v192, v193
  v_add_f32 v14, v194, v195
  v_add_f32 v15, v196, v197
  v_add_f32 v16, v198, v199
  v_mfma_f32_16x16x32_bf16 v[28:31], v[108:111], v[36:39], v[28:31]
  v_add_f32 v13, v13, v14
  v_add_f32 v15, v15, v16
  v_add_f32 v12, v12, v13
  v_add_f32 v12, v12, v15
  s_add_u32 s64, s64, 1
  s_cmp_lg_u32 s64, s65
  s_cbranch_scc1 L_nowo2
  s_mul_i32 s47, s52, 294912
  s_mul_i32 s48, s57, 144
  s_add_u32 s47, s47, s48
  s_add_u32 s28, s12, s47
  s_addc_u32 s29, s13, 0
  s_sub_u32 s30, 4718592, s47
  s_lshr_b32 s47, s40, 2
  s_lshl_b32 s47, s47, 7
  s_and_b32 s48, s40, 3
  s_lshl_b32 s48, s48, 1
  s_add_u32 s47, s47, s48
  s_mul_i32 s54, s47, 1152
  v_min_u32 v15, 8, v3
  v_lshlrev_b32 v15, 4, v15
  v_mul_u32_u24 v16, 36864, v2
  v_add_u32 v6, v15, v16
  buffer_load_dwordx4 v[204:207], v6, s[28:31], s54 offen offset:0 nt
  buffer_load_dwordx4 v[208:211], v6, s[28:31], s54 offen offset:1152 nt
  s_add_u32 s54, s54, 9216
  buffer_load_dwordx4 v[212:215], v6, s[28:31], s54 offen offset:0 nt
  buffer_load_dwordx4 v[216:219], v6, s[28:31], s54 offen offset:1152 nt
  s_add_u32 s54, s54, 9216
  buffer_load_dwordx4 v[220:223], v6, s[28:31], s54 offen offset:0 nt
  buffer_load_dwordx4 v[224:227], v6, s[28:31], s54 offen offset:1152 nt
  s_add_u32 s54, s54, 9216
  buffer_load_dwordx4 v[228:231], v6, s[28:31], s54 offen offset:0 nt
  buffer_load_dwordx4 v[232:235], v6, s[28:31], s54 offen offset:1152 nt
L_nowo2:
  s_cmp_gt_u32 s62, s49
  s_cbranch_scc1 L_exit
  s_lshl_b32 s47, s63, 14
  v_add_u32 v40, s47, v5
  s_lshl_b32 s48, s62, 1
  s_add_u32 s48, s48, 1
L_kspinB:
  ds_read_b64 v[42:43], v26
  s_waitcnt lgkmcnt(0)
  v_readfirstlane_b32 s66, v42
  v_readfirstlane_b32 s49, v43
  s_sub_u32 s49, s49, 1
  s_cmp_ge_i32 s66, s48
  s_cbranch_scc1 L_kokB
  s_cmp_gt_u32 s62, s49
  s_cbranch_scc1 L_exit
  s_sleep 1
  s_sub_u32 s58, s58, 1
  s_cmp_lg_u32 s58, 0
  s_cbranch_scc1 L_kspinB
L_kokB:
  ds_read_b128 v[48:51], v40 offset:0
  ds_read_b128 v[52:55], v40 offset:1024
  ds_read_b128 v[56:59], v40 offset:2048
  ds_read_b128 v[60:63], v40 offset:3072
  ds_read_b128 v[64:67], v40 offset:4096
  ds_read_b128 v[68:71], v40 offset:5120
  ds_read_b128 v[72:75], v40 offset:6144
  ds_read_b128 v[76:79], v40 offset:7168
  s_lshl_b32 s47, s63, 2
  s_add_u32 s67, s47, 160416
  s_add_u32 s68, s62, 1
  s_add_u32 s69, s48, 1
  s_mov_b32 s70, 1
  s_waitcnt lgkmcnt(0)
  s_branch L_loop
L_exit:
  v_mov_b32 v14, v12
  s_nop 1
  v_permlane32_swap_b32 v12, v14
  v_add_f32 v12, v12, v14
  v_mov_b32 v14, v12
  s_nop 1
  v_permlane16_swap_b32 v12, v14
  v_add_f32 v12, v12, v14
  s_lshl_b32 s47, s40, 10
  s_add_u32 s47, s47, 147456
  v_add_u32 v13, s47, v5
  ds_write_b128 v13, v[28:31]
  v_and_b32 v13, 8, v3
  s_lshl_b32 s47, s40, 4
  s_add_u32 s47, s47, 160256
  v_add_u32 v14, s47, v13
  v_mov_b32 v192, v11
  v_mov_b32 v193, v12
  ds_write_b64 v14, v[192:193]
  v_lshrrev_b32 v15, 1, v3
  v_lshlrev_b32 v15, 11, v15
  v_and_b32 v16, 1, v3
  v_lshl_add_u32 v16, v2, 4, v16
  s_lshl_b32 s47, s40, 1
  v_add_u32 v16, s47, v16
  v_lshl_add_u32 v4, v16, 4, v15
  v_and_b32 v16, 1, v3
  v_lshl_add_u32 v16, v2, 1, v16
  v_lshl_add_u32 v4, v16, 4, v15
  s_lshl_b32 s47, s40, 7
  v_add_u32 v4, s47, v4
  v_lshrrev_b32 v8, 1, v3
  v_lshlrev_b32 v8, 7, v8
  v_lshl_add_u32 v8, v16, 4, v8
  s_lshr_b32 s47, s40, 2
  s_lshl_b32 s47, s47, 3
  s_add_u32 s47, s47, 1264
  v_add_u32 v7, s47, v15
  s_lshl_b32 s54, s56, 14
  v_add_u32 v40, 147456, v5
  v_add_u32 v41, 160256, v13
  s_waitcnt lgkmcnt(0)
  s_barrier
  s_cmp_lg_u32 s40, 0
  s_cbranch_scc1 L_poll1_pre
  ds_read_b128 v[48:51], v40 offset:0
  ds_read_b128 v[52:55], v40 offset:1024
  ds_read_b128 v[56:59], v40 offset:2048
  ds_read_b128 v[60:63], v40 offset:3072
  ds_read_b128 v[64:67], v40 offset:4096
  ds_read_b128 v[68:71], v40 offset:5120
  ds_read_b128 v[72:75], v40 offset:6144
  ds_read_b128 v[76:79], v40 offset:7168
  ds_read_b64 v[80:81], v41 offset:0
  ds_read_b64 v[82:83], v41 offset:16
  ds_read_b64 v[84:85], v41 offset:32
  ds_read_b64 v[86:87], v41 offset:48
  ds_read_b64 v[88:89], v41 offset:64
  ds_read_b64 v[90:91], v41 offset:80
  ds_read_b64 v[92:93], v41 offset:96
  ds_read_b64 v[94:95], v41 offset:112
  s_waitcnt lgkmcnt(0)
  v_max3_f32 v10, v80, v82, v84
  v_max3_f32 v14, v86, v88, v90
  v_max3_f32 v10, v10, v92, v94
  v_max_f32 v10, v10, v14
  v_sub_f32 v80, v80, v10
  v_sub_f32 v82, v82, v10
  v_sub_f32 v84, v84, v10
  v_sub_f32 v86, v86, v10
  v_sub_f32 v88, v88, v10
  v_sub_f32 v90, v90, v10
  v_sub_f32 v92, v92, v10
  v_sub_f32 v94, v94, v10
  v_exp_f32 v80, v80
  v_exp_f32 v82, v82
  v_exp_f32 v84, v84
  v_exp_f32 v86, v86
  v_exp_f32 v88, v88
  v_exp_f32 v90, v90
  v_exp_f32 v92, v92
  v_exp_f32 v94, v94
  s_nop 0
  v_mul_f32 v192, v48, v80
  v_mul_f32 v193, v49, v80
  v_mul_f32 v194, v50, v80
  v_mul_f32 v195, v51, v80
  v_mul_f32 v197, v81, v80
  v_fma_f32 v192, v52, v82, v192
  v_fma_f32 v193, v53, v82, v193
  v_fma_f32 v194, v54, v82, v194
  v_fma_f32 v195, v55, v82, v195
  v_fma_f32 v197, v83, v82, v197
  v_fma_f32 v192, v56, v84, v192
  v_fma_f32 v193, v57, v84, v193
  v_fma_f32 v194, v58, v84, v194
  v_fma_f32 v195, v59, v84, v195
  v_fma_f32 v197, v85, v84, v197
  v_fma_f32 v192, v60, v86, v192
  v_fma_f32 v193, v61, v86, v193
  v_fma_f32 v194, v62, v86, v194
  v_fma_f32 v195, v63, v86, v195
  v_fma_f32 v197, v87, v86, v197
  v_fma_f32 v192, v64, v88, v192
  v_fma_f32 v193, v65, v88, v193
  v_fma_f32 v194, v66, v88, v194
  v_fma_f32 v195, v67, v88, v195
  v_fma_f32 v197, v89, v88, v197
  v_fma_f32 v192, v68, v90, v192
  v_fma_f32 v193, v69, v90, v193
  v_fma_f32 v194, v70, v90, v194
  v_fma_f32 v195, v71, v90, v195
  v_fma_f32 v197, v91, v90, v197
  v_fma_f32 v192, v72, v92, v192
  v_fma_f32 v193, v73, v92, v193
  v_fma_f32 v194, v74, v92, v194
  v_fma_f32 v195, v75, v92, v195
  v_fma_f32 v197, v93, v92, v197
  v_fma_f32 v192, v76, v94, v192
  v_fma_f32 v193, v77, v94, v193
  v_fma_f32 v194, v78, v94, v194
  v_fma_f32 v195, v79, v94, v195
  v_fma_f32 v197, v95, v94, v197
  s_mov_b32 s60, 0xaaaaaaaa
  s_mov_b32 s61, 0xaaaaaaaa
  v_cndmask_b32 v196, v10, v197, s[60:61]
  v_min_u32 v192, 0xfffffe00, v192
  v_min_u32 v193, 0xfffffe00, v193
  v_min_u32 v194, 0xfffffe00, v194
  v_min_u32 v195, 0xfffffe00, v195
  s_mov_b32 s47, 0x07060500
  v_perm_b32 v192, v192, v196, s47
  s_mov_b32 s47, 0x07060501
  v_perm_b32 v193, v193, v196, s47
  s_mov_b32 s47, 0x07060502
  v_perm_b32 v194, v194, v196, s47
  s_mov_b32 s47, 0x07060503
  v_perm_b32 v195, v195, v196, s47
  buffer_store_dwordx4 v[192:195], v8, s[36:39], s55 offen sc1
L_poll1_pre:
L_poll1:
  buffer_load_dwordx4 v[112:115], v4, s[36:39], s54 offen sc1
  s_waitcnt vmcnt(0)
  v_max3_u32 v13, v112, v113, v114
  v_max_u32 v13, v13, v115
  v_cmp_eq_u32 vcc, -1, v13
  s_cbranch_vccz L_poll1_done
  s_sub_u32 s58, s58, 1
  s_cmp_lg_u32 s58, 0
  s_cbranch_scc1 L_poll1
L_poll1_done:
  s_mov_b32 s47, 0x0c0c0400
  s_mov_b32 s48, 0x04000c0c
  v_perm_b32 v13, v113, v112, s47
  v_perm_b32 v14, v115, v114, s48
  v_or_b32 v13, v13, v14
  s_nop 1
  v_mov_b32_dpp v116, v13 quad_perm:[0,0,2,2] row_mask:0xf bank_mask:0xf
  v_mov_b32_dpp v117, v13 quad_perm:[1,1,3,3] row_mask:0xf bank_mask:0xf
  v_mov_b32 v13, v116
  s_nop 1
  v_max_f32_dpp v13, v13, v13 row_ror:2 row_mask:0xf bank_mask:0xf
  s_nop 1
  v_max_f32_dpp v13, v13, v13 row_ror:4 row_mask:0xf bank_mask:0xf
  s_nop 1
  v_max_f32_dpp v13, v13, v13 row_ror:8 row_mask:0xf bank_mask:0xf
  s_nop 1
  v_sub_f32 v14, v116, v13
  v_exp_f32 v14, v14
  s_nop 0
  v_mul_f32 v112, v112, v14
  v_mul_f32 v113, v113, v14
  v_mul_f32 v114, v114, v14
  v_mul_f32 v115, v115, v14
  v_mul_f32 v117, v117, v14
  v_add_f32_dpp v112, v112, v112 row_ror:2 row_mask:0xf bank_mask:0xf
  v_add_f32_dpp v113, v113, v113 row_ror:2 row_mask:0xf bank_mask:0xf
  v_add_f32_dpp v114, v114, v114 row_ror:2 row_mask:0xf bank_mask:0xf
  v_add_f32_dpp v115, v115, v115 row_ror:2 row_mask:0xf bank_mask:0xf
  v_add_f32_dpp v117, v117, v117 row_ror:2 row_mask:0xf bank_mask:0xf
  v_add_f32_dpp v112, v112, v112 row_ror:4 row_mask:0xf bank_mask:0xf
  v_add_f32_dpp v113, v113, v113 row_ror:4 row_mask:0xf bank_mask:0xf
  v_add_f32_dpp v114, v114, v114 row_ror:4 row_mask:0xf bank_mask:0xf
  v_add_f32_dpp v115, v115, v115 row_ror:4 row_mask:0xf bank_mask:0xf
  v_add_f32_dpp v117, v117, v117 row_ror:4 row_mask:0xf bank_mask:0xf
  v_add_f32_dpp v112, v112, v112 row_ror:8 row_mask:0xf bank_mask:0xf
  v_add_f32_dpp v113, v113, v113 row_ror:8 row_mask:0xf bank_mask:0xf
  v_add_f32_dpp v114, v114, v114 row_ror:8 row_mask:0xf bank_mask:0xf
  v_add_f32_dpp v115, v115, v115 row_ror:8 row_mask:0xf bank_mask:0xf
  v_add_f32_dpp v117, v117, v117 row_ror:8 row_mask:0xf bank_mask:0xf
  v_rcp_f32 v14, v117
  s_nop 0
  v_mul_f32 v112, v112, v14
  v_mul_f32 v113, v113, v14
  v_mul_f32 v114, v114, v14
  v_mul_f32 v115, v115, v14
  v_cvt_pk_bf16_f32 v13, v112, v113
  v_cvt_pk_bf16_f32 v14, v114, v115
  s_nop 1
  v_mov_b32_dpp v200, v13 row_newbcast:0 row_mask:0xf bank_mask:0xf
  v_mov_b32_dpp v201, v14 row_newbcast:0 row_mask:0xf bank_mask:0xf
  v_mov_b32_dpp v202, v13 row_newbcast:1 row_mask:0xf bank_mask:0xf
  v_mov_b32_dpp v203, v14 row_newbcast:1 row_mask:0xf bank_mask:0xf
  v_perm_b32 v32, v200, v200, v18
  v_perm_b32 v33, v200, v200, v20
  v_perm_b32 v34, v200, v200, v22
  v_perm_b32 v35, v200, v200, v24
  v_perm_b32 v36, v200, v200, v19
  v_perm_b32 v37, v200, v200, v21
  v_perm_b32 v38, v200, v200, v23
  v_perm_b32 v39, v200, v200, v25
  v_mfma_f32_16x16x32_bf16 v[28:31], v[204:207], v[32:35], 0
  v_perm_b32 v32, v201, v201, v18
  v_perm_b32 v33, v201, v201, v20
  v_perm_b32 v34, v201, v201, v22
  v_perm_b32 v35, v201, v201, v24
  v_mfma_f32_16x16x32_bf16 v[28:31], v[212:215], v[36:39], v[28:31]
  v_perm_b32 v36, v201, v201, v19
  v_perm_b32 v37, v201, v201, v21
  v_perm_b32 v38, v201, v201, v23
  v_perm_b32 v39, v201, v201, v25
  v_mfma_f32_16x16x32_bf16 v[28:31], v[220:223], v[32:35], v[28:31]
  v_perm_b32 v32, v202, v202, v18
  v_perm_b32 v33, v202, v202, v20
  v_perm_b32 v34, v202, v202, v22
  v_perm_b32 v35, v202, v202, v24
  v_mfma_f32_16x16x32_bf16 v[28:31], v[228:231], v[36:39], v[28:31]
  v_perm_b32 v36, v202, v202, v19
  v_perm_b32 v37, v202, v202, v21
  v_perm_b32 v38, v202, v202, v23
  v_perm_b32 v39, v202, v202, v25
  v_mfma_f32_16x16x32_bf16 v[28:31], v[208:211], v[32:35], v[28:31]
  v_perm_b32 v32, v203, v203, v18
  v_perm_b32 v33, v203, v203, v20
  v_perm_b32 v34, v203, v203, v22
  v_perm_b32 v35, v203, v203, v24
  v_mfma_f32_16x16x32_bf16 v[28:31], v[216:219], v[36:39], v[28:31]
  v_perm_b32 v36, v203, v203, v19
  v_perm_b32 v37, v203, v203, v21
  v_perm_b32 v38, v203, v203, v23
  v_perm_b32 v39, v203, v203, v25
  v_mfma_f32_16x16x32_bf16 v[28:31], v[224:227], v[32:35], v[28:31]
  s_nop 1
  v_mfma_f32_16x16x32_bf16 v[28:31], v[232:235], v[36:39], v[28:31]
  v_and_b32 v13, 7, v3
  v_lshlrev_b32 v13, 2, v13
  v_lshl_add_u32 v13, v2, 7, v13
  s_lshl_b32 s47, s40, 9
  s_add_u32 s47, s47, 155648
  v_add_u32 v13, s47, v13
  s_nop 4
  ds_write_b32 v13, v28 offset:0
  ds_write_b32 v13, v29 offset:32
  ds_write_b32 v13, v30 offset:64
  ds_write_b32 v13, v31 offset:96
  s_waitcnt lgkmcnt(0)
  s_barrier
  s_cmp_eq_u32 s40, 1
  s_cbranch_scc1 L_final
  s_cmp_lg_u32 s40, 0
  s_cbranch_scc1 L_stamp
  v_min_u32 v13, 17, v1
  v_lshlrev_b32 v13, 4, v13
  v_add_u32 v14, 155648, v13
  ds_read_b128 v[48:51], v14 offset:0
  ds_read_b128 v[52:55], v14 offset:512
  ds_read_b128 v[56:59], v14 offset:1024
  ds_read_b128 v[60:63], v14 offset:1536
  ds_read_b128 v[64:67], v14 offset:2048
  ds_read_b128 v[68:71], v14 offset:2560
  ds_read_b128 v[72:75], v14 offset:3072
  ds_read_b128 v[76:79], v14 offset:3584
  s_waitcnt lgkmcnt(0)
  v_add_f32 v48, v48, v52
  v_add_f32 v49, v49, v53
  v_add_f32 v50, v50, v54
  v_add_f32 v51, v51, v55
  v_add_f32 v56, v56, v60
  v_add_f32 v57, v57, v61
  v_add_f32 v58, v58, v62
  v_add_f32 v59, v59, v63
  v_add_f32 v64, v64, v68
  v_add_f32 v65, v65, v69
  v_add_f32 v66, v66, v70
  v_add_f32 v67, v67, v71
  v_add_f32 v72, v72, v76
  v_add_f32 v73, v73, v77
  v_add_f32 v74, v74, v78
  v_add_f32 v75, v75, v79
  v_add_f32 v48, v48, v56
  v_add_f32 v49, v49, v57
  v_add_f32 v50, v50, v58
  v_add_f32 v51, v51, v59
  v_add_f32 v64, v64, v72
  v_add_f32 v65, v65, v73
  v_add_f32 v66, v66, v74
  v_add_f32 v67, v67, v75
  v_add_f32 v48, v48, v64
  v_add_f32 v49, v49, v65
  v_add_f32 v50, v50, v66
  v_add_f32 v51, v51, v67
  v_min_u32 v48, 0xfffffffe, v48
  v_min_u32 v49, 0xfffffffe, v49
  v_min_u32 v50, 0xfffffffe, v50
  v_min_u32 v51, 0xfffffffe, v51
  s_mov_b64 exec, 0x3ffff
  buffer_store_dwordx4 v[48:51], v13, s[36:39], s43 offen offset:1280 sc1
  s_mov_b64 exec, -1
  s_branch L_stamp
L_final:
  s_lshl_b32 s47, s57, 1
  s_add_u32 s47, s47, s53
  s_cmp_lg_u32 s47, s52
  s_cbranch_scc1 L_stamp
  v_and_b32 v13, 31, v1
  v_min_u32 v13, 17, v13
  v_lshlrev_b32 v13, 4, v13
  v_lshrrev_b32 v14, 5, v1
  v_lshl_add_u32 v13, v14, 14, v13
  s_lshl_b32 s47, s53, 7
  s_add_u32 s47, s47, s57
  s_lshl_b32 s47, s47, 11
  s_add_u32 s59, s47, 1280
L_poll2:
  s_mov_b32 s54, s59
  buffer_load_dwordx4 v[48:51], v13, s[36:39], s54 offen sc1
  s_add_u32 s54, s54, 0x8000
  buffer_load_dwordx4 v[52:55], v13, s[36:39], s54 offen sc1
  s_add_u32 s54, s54, 0x8000
  buffer_load_dwordx4 v[56:59], v13, s[36:39], s54 offen sc1
  s_add_u32 s54, s54, 0x8000
  buffer_load_dwordx4 v[60:63], v13, s[36:39], s54 offen sc1
  s_add_u32 s54, s54, 0x8000
  buffer_load_dwordx4 v[64:67], v13, s[36:39], s54 offen sc1
  s_add_u32 s54, s54, 0x8000
  buffer_load_dwordx4 v[68:71], v13, s[36:39], s54 offen sc1
  s_add_u32 s54, s54, 0x8000
  buffer_load_dwordx4 v[72:75], v13, s[36:39], s54 offen sc1
  s_add_u32 s54, s54, 0x8000
  buffer_load_dwordx4 v[76:79], v13, s[36:39], s54 offen sc1
  s_waitcnt vmcnt(0)
  v_max3_u32 v14, v48, v49, v50
  v_max3_u32 v14, v14, v51, v52
  v_max3_u32 v14, v14, v53, v54
  v_max3_u32 v14, v14, v55, v56
  v_max3_u32 v14, v14, v57, v58
  v_max3_u32 v14, v14, v59, v60
  v_max3_u32 v14, v14, v61, v62
  v_max3_u32 v14, v14, v63, v64
  v_max3_u32 v14, v14, v65, v66
  v_max3_u32 v14, v14, v67, v68
  v_max3_u32 v14, v14, v69, v70
  v_max3_u32 v14, v14, v71, v72
  v_max3_u32 v14, v14, v73, v74
  v_max3_u32 v14, v14, v75, v76
  v_max3_u32 v14, v14, v77, v78
  v_max_u32 v14, v14, v79
  v_cmp_eq_u32 vcc, -1, v14
  s_cbranch_vccz L_poll2_done
  s_sub_u32 s58, s58, 1
  s_cmp_lg_u32 s58, 0
  s_cbranch_scc1 L_poll2
L_poll2_done:
  v_add_f32 v48, v48, v52
  v_add_f32 v49, v49, v53
  v_add_f32 v50, v50, v54
  v_add_f32 v51, v51, v55
  v_add_f32 v56, v56, v60
  v_add_f32 v57, v57, v61
  v_add_f32 v58, v58, v62
  v_add_f32 v59, v59, v63
  v_add_f32 v64, v64, v68
  v_add_f32 v65, v65, v69
  v_add_f32 v66, v66, v70
  v_add_f32 v67, v67, v71
  v_add_f32 v72, v72, v76
  v_add_f32 v73, v73, v77
  v_add_f32 v74, v74, v78
  v_add_f32 v75, v75, v79
  v_add_f32 v48, v48, v56
  v_add_f32 v49, v49, v57
  v_add_f32 v50, v50, v58
  v_add_f32 v51, v51, v59
  v_add_f32 v64, v64, v72
  v_add_f32 v65, v65, v73
  v_add_f32 v66, v66, v74
  v_add_f32 v67, v67, v75
  v_add_f32 v48, v48, v64
  v_add_f32 v49, v49, v65
  v_add_f32 v50, v50, v66
  v_add_f32 v51, v51, v67
  v_mov_b32 v52, v48
  v_mov_b32 v53, v49
  v_mov_b32 v54, v50
  v_mov_b32 v55, v51
  s_nop 1
  v_permlane32_swap_b32 v48, v52
  v_permlane32_swap_b32 v49, v53
  v_permlane32_swap_b32 v50, v54
  v_permlane32_swap_b32 v51, v55
  v_add_f32 v48, v48, v52
  v_add_f32 v49, v49, v53
  v_add_f32 v50, v50, v54
  v_add_f32 v51, v51, v55
  v_cvt_pk_bf16_f32 v56, v48, v49
  v_cvt_pk_bf16_f32 v57, v50, v51
  s_mov_b32 s32, s14
  s_mov_b32 s33, s15
  s_mov_b32 s34, 2304
  s_mul_i32 s47, s53, 1152
  s_mul_i32 s48, s57, 144
  s_add_u32 s47, s47, s48
  v_lshlrev_b32 v13, 3, v1
  s_mov_b64 exec, 0x3ffff
  buffer_store_dwordx2 v[56:57], v13, s[32:35], s47 offen
  s_mov_b64 exec, -1
L_stamp:
L_end:
  s_endpgm
.section .rodata,"a"
.p2align 6
.amdhsa_kernel standalone__gqa_block_cached__decode_kernel
  .amdhsa_next_free_vgpr 256
  .amdhsa_next_free_sgpr 100
  .amdhsa_accum_offset 256
  .amdhsa_group_segment_fixed_size 0
  .amdhsa_kernarg_size 64
  .amdhsa_user_sgpr_count 2
  .amdhsa_user_sgpr_kernarg_segment_ptr 1
  .amdhsa_system_sgpr_workgroup_id_x 1
.end_amdhsa_kernel
```
